```python
import torch

def _softmax(x, axis=-1):
    return torch.softmax(x, dim=axis)
def _gelu(x):
    return torch.nn.functional.gelu(x, approximate="tanh")
def _silu(x):
    return torch.nn.functional.silu(x)
def _sigmoid(x):
    return torch.sigmoid(x)
def _layernorm(x, axis=-1, eps=1e-5):
    m = x.mean(dim=axis, keepdim=True)
    v = x.var(dim=axis, keepdim=True, unbiased=False)
    return (x - m) / torch.sqrt(v + eps)
def _scatter_add(tgt, idx, src, axis=0):
    return tgt.clone().index_add_(axis, idx, src)
def _segment_sum(src, seg, n):
    out = torch.zeros((n,) + src.shape[1:], dtype=src.dtype)
    return out.index_add_(0, seg, src)
def _pad(x, pw):
    flat = tuple(v for pair in reversed(pw) for v in pair)
    return torch.nn.functional.pad(x, flat)

kernel_name = 'recurrent_scan__ssm_conv_s5__dense_activation_silu__prompt'

def setup_inputs():

    _w = (lambda a: (lambda t: t.to(torch.bfloat16) if t.is_floating_point() else t)(torch.as_tensor(a)))
    def _A_setup():
        B, S, D = 1, 2048, 512
        P = D
        Lambda_re = -0.5 * (lambda _x: torch.exp(torch.as_tensor(_x)))((lambda *s: torch.randn(*s, dtype=torch.bfloat16) * 0.8)(P))
        Lambda_im = (lambda *s: torch.randn(*s, dtype=torch.bfloat16) * 0.8)(P) * 1.0
        B_re = (lambda *s: torch.randn(*s, dtype=torch.bfloat16) * 0.8)(P, D) * (D ** -0.5)
        B_im = (lambda *s: torch.randn(*s, dtype=torch.bfloat16) * 0.8)(P, D) * (D ** -0.5)
        C_re = (lambda *s: torch.randn(*s, dtype=torch.bfloat16) * 0.8)(D, P) * (P ** -0.5)
        C_im = (lambda *s: torch.randn(*s, dtype=torch.bfloat16) * 0.8)(D, P) * (P ** -0.5)
        log_dt = (lambda *s: torch.randn(*s, dtype=torch.bfloat16) * 0.8)(P) * 0.3 - 2.0
        Dskip = (lambda *s: torch.randn(*s, dtype=torch.bfloat16) * 0.8)(D)
        return {
            "x": _w((lambda *s: torch.randn(*s, dtype=torch.bfloat16) * 0.05)(B, S, D)),
            "Lambda_re": _w(Lambda_re),
            "Lambda_im": _w(Lambda_im),
            "B_re": _w(B_re),
            "B_im": _w(B_im),
            "C_re": _w(C_re),
            "C_im": _w(C_im),
            "log_dt": _w(log_dt),
            "Dskip": _w(Dskip),
        }
    _A_in = _A_setup()

    def _B_setup():
        B, S, D, F = 1, 2048, 512, 1792
        return {
            "x": _w((lambda *s: torch.randn(*s, dtype=torch.bfloat16) * 0.05)(B, S, D)),
            "w1": _w((lambda *s: torch.randn(*s, dtype=torch.bfloat16) * 0.8)(D, F) * (D ** -0.5)),
            "w2": _w((lambda *s: torch.randn(*s, dtype=torch.bfloat16) * 0.2)(F, D) * (F ** -0.5)),
        }
    _B_in = _B_setup()

    return {
        "A_x": _A_in["x"],
        "A_Lambda_re": _A_in["Lambda_re"],
        "A_Lambda_im": _A_in["Lambda_im"],
        "A_B_re": _A_in["B_re"],
        "A_B_im": _A_in["B_im"],
        "A_C_re": _A_in["C_re"],
        "A_C_im": _A_in["C_im"],
        "A_log_dt": _A_in["log_dt"],
        "A_Dskip": _A_in["Dskip"],
        "B_x": _B_in["x"],
        "B_w1": _B_in["w1"],
        "B_w2": _B_in["w2"],
    }

def reference(A_x, A_Lambda_re, A_Lambda_im, A_B_re, A_B_im, A_C_re, A_C_im, A_log_dt, A_Dskip, B_x, B_w1, B_w2):
    def _A_ref(x, Lambda_re, Lambda_im, B_re, B_im, C_re, C_im, log_dt, Dskip):
        Bsz, L, H = x.shape
        Lam = Lambda_re + 1j * Lambda_im
        Bmat = B_re + 1j * B_im
        Cmat = C_re + 1j * C_im
        dt = torch.exp(log_dt)
        Lam_bar = torch.exp(dt * Lam)
        B_bar = ((Lam_bar - 1.0) / Lam)[:, None] * Bmat
        Bu = torch.einsum("bld,pd->blp", x + 0j, B_bar)
        h = torch.zeros_like(Bu[:, 0, :])
        hs = []
        for t in range(L):
            h = Lam_bar[None, :] * h + Bu[:, t, :]
            hs.append(h)
        hseq = torch.stack(hs, 1)
        y = 2.0 * torch.einsum("blp,dp->bld", hseq, Cmat).real + x * Dskip[None, None, :]
        return y

    def _B_ref(x, w1, w2):
        h = torch.einsum("bsd,df->bsf", x, w1)
        h = _silu(h)
        out = torch.einsum("bsf,fd->bsd", h, w2)
        return out

    x = A_x
    xn = _layernorm(x, axis=-1)
    s = _A_ref(xn, A_Lambda_re, A_Lambda_im, A_B_re, A_B_im, A_C_re, A_C_im, A_log_dt, A_Dskip)
    g = _silu(_B_ref(xn, B_w1, B_w2))
    return x + s * g
```

```asm
; @launch grid=(256,1,1) block=(512,1,1) lds=163840
.amdgcn_target "amdgcn-amd-amdhsa--gfx950"
.text
.globl recurrent_scan__ssm_conv_s5__dense_activation_silu__prompt_kernel
.p2align 8
.type recurrent_scan__ssm_conv_s5__dense_activation_silu__prompt_kernel,@function
recurrent_scan__ssm_conv_s5__dense_activation_silu__prompt_kernel:
main_kernel:
    s_cmp_ge_u32 s2, 256
    s_cbranch_scc1 K_END
    s_load_dwordx16 s[16:31], s[0:1], 0
    s_load_dwordx2 s[32:33], s[0:1], 64
    s_load_dwordx8 s[36:43], s[0:1], 80
    s_load_dwordx2 s[34:35], s[0:1], 112
    s_getpc_b64 s[44:45]
    s_lshr_b32 s100, s2, 3
    s_lshl_b32 s6, s100, 11
    v_lshl_add_u32 v4, v0, 7, s6
    v_min_u32 v4, CODE_END-main_kernel-64, v4
    v_cmp_gt_u32 vcc, 16, v0
    s_nop 0
    s_and_b64 exec, exec, vcc
    s_cbranch_execz NOCT
    global_load_dword v27, v4, s[44:45]
NOCT:
    s_nop 0
    s_mov_b64 exec, -1
    v_lshrrev_b32 v4, 6, v0
    s_nop 0
    v_readfirstlane_b32 s3, v4
    v_and_b32 v1, 63, v0
    v_and_b32 v2, 15, v0
    v_lshrrev_b32 v3, 4, v1
    s_and_b32 s6, s2, 6
    s_lshl_b32 s6, s6, 1
    s_and_b32 s7, s100, 3
    s_add_u32 s4, s6, s7
    s_and_b32 s78, s2, 1
    s_lshr_b32 s79, s2, 5
    s_lshl_b32 s6, s78, 3
    s_add_u32 s5, s6, s79
    s_lshr_b32 s7, s6, 1
    s_lshr_b32 s78, s79, 2
    s_and_b32 s79, s79, 3
    s_or_b32 s79, s79, s7
    s_add_u32 s13, s79, s4
    s_and_b32 s76, s3, 3
    s_lshr_b32 s77, s3, 2
    s_and_b32 s13, s13, 3
    s_lshl_b32 s13, s13, 8
    s_lshl_b32 s8, s4, 5
    s_lshl_b32 s6, s76, 3
    s_add_u32 s8, s8, s6
    s_add_u32 s8, s8, s77
    s_lshl_b32 s8, s8, 12
    s_mul_i32 s85, s3, 20480
    s_lshl_b32 s11, s5, 3
    s_add_u32 s11, s11, s3
    s_lshl_b32 s11, s11, 12
    v_lshlrev_b32 v4, 2, v3
    v_xor_b32 v4, v4, v2
    v_lshlrev_b32 v4, 4, v4
    v_lshl_or_b32 v120, v3, 13, v4
    v_xor_b32 v121, 16, v120
    v_xor_b32 v122, 32, v120
    v_xor_b32 v123, 48, v120
    s_lshl_b32 s7, s76, 2
    v_xor_b32 v4, v3, v2
    v_xor_b32 v4, s7, v4
    v_lshlrev_b32 v9, 4, v4
    v_lshl_or_b32 v22, v3, 10, v9
    s_lshl_b32 s6, s5, 6
    s_lshl_b32 s7, s77, 5
    s_add_u32 s6, s6, s7
    v_lshl_add_u32 v5, v2, 1, s6
    s_add_u32 s10, s8, s13
    s_add_u32 s9, s11, s13
    s_add_u32 m0, s85, 14336
    s_waitcnt lgkmcnt(0)
    s_mov_b32 s48, s16
    s_mov_b32 s49, s17
    s_mov_b32 s50, 2097152
    s_mov_b32 s51, 0x20000
    buffer_load_dwordx4 v120, s[48:51], s10 offen offset:0 lds
    buffer_load_dwordx4 v121, s[48:51], s10 offen offset:1024 lds
    buffer_load_dwordx4 v122, s[48:51], s10 offen offset:2048 lds
    buffer_load_dwordx4 v123, s[48:51], s10 offen offset:3072 lds
    s_mov_b32 s56, s22
    s_mov_b32 s57, s23
    s_mov_b32 s58, 524288
    s_mov_b32 s59, 0x20000
    s_mov_b32 s64, s24
    s_mov_b32 s65, s25
    s_mov_b32 s66, 524288
    s_mov_b32 s67, 0x20000
    s_cmp_lg_u32 s77, 0
    s_cbranch_scc1 WOA
    s_add_u32 m0, s85, 0
    s_nop 0
    buffer_load_dwordx4 v22, s[56:59], s9 offen lds
    s_add_u32 m0, s85, 1024
    s_nop 0
    buffer_load_dwordx4 v22, s[64:67], s9 offen lds
WOA:
    global_load_ushort v60, v5, s[18:19]
    global_load_ushort v61, v5, s[20:21]
    global_load_ushort v62, v5, s[30:31]
    s_mov_b32 s60, s34
    s_mov_b32 s61, s35
    s_mov_b32 s62, 15728640
    s_mov_b32 s63, 0x20000
    s_cmp_lg_u32 s5, 0
    s_cbranch_scc1 NOZERO
    s_lshl_b32 s6, s4, 12
    s_lshl_b32 s7, s3, 9
    s_add_u32 s6, s6, s7
    s_add_u32 s6, s6, 13631488
    v_lshlrev_b32 v5, 3, v1
    v_mov_b32 v6, 0
    v_mov_b32 v7, 0
    buffer_store_dwordx2 v[6:7], v5, s[60:63], s6 offen sc1
    s_cmp_gt_u32 s3, 0
    s_cbranch_scc1 NOZERO
    s_lshl_b32 s6, s4, 11
    s_add_u32 s6, s6, 13697024
    v_lshlrev_b32 v5, 5, v1
    buffer_store_dword v6, v5, s[60:63], s6 offen sc1
NOZERO:
    s_nop 0
    v_and_b32 v4, 3, v2
    v_lshrrev_b32 v5, 2, v2
    v_lshlrev_b32 v6, 10, v4
    v_lshl_add_u32 v6, v5, 8, v6
    v_add3_u32 v10, v6, v9, s85
    v_mul_u32_u24 v6, 20480, v5
    v_lshl_add_u32 v6, v4, 8, v6
    s_mul_i32 s6, s77, 81920
    v_add3_u32 v14, v6, v9, s6
    s_xor_b32 s6, s3, 4
    s_mul_i32 s6, s6, 20480
    s_sub_u32 s6, s6, s85
    v_add_u32 v18, s6, v10
    v_xor_b32 v11, 64, v10
    v_xor_b32 v19, 64, v18
    v_xor_b32 v15, 64, v14
    v_xor_b32 v12, 128, v10
    v_xor_b32 v20, 128, v18
    v_xor_b32 v16, 128, v14
    v_xor_b32 v13, 192, v10
    v_xor_b32 v21, 192, v18
    v_xor_b32 v17, 192, v14
    v_mov_b32 v56, 0x3f803f80
    v_mov_b32 v57, 0x3f803f80
    v_mov_b32 v58, 0x3f803f80
    v_mov_b32 v59, 0x3f803f80
    v_mov_b32 v125, 0
    v_mov_b32 v126, 0
    v_mov_b32 v127, 0
    v_cmp_eq_u32 s[90:91], 1, v4
    v_cmp_eq_u32 s[92:93], 2, v4
    v_cmp_eq_u32 s[94:95], 3, v4
    v_cmp_eq_u32 s[46:47], v5, v3
    s_mov_b32 s52, s36
    s_mov_b32 s53, s37
    s_mov_b32 s54, 1835008
    s_mov_b32 s55, 0x20000
    v_lshrrev_b32 v6, 2, v1
    v_mul_u32_u24 v6, 3584, v6
    v_lshrrev_b32 v7, 5, v1
    v_lshlrev_b32 v7, 1, v7
    v_and_b32 v8, 3, v1
    v_xor_b32 v7, v7, v8
    v_lshl_add_u32 v23, v7, 4, v6
    v_bfe_u32 v6, v1, 3, 2
    v_lshlrev_b32 v6, 3, v6
    v_lshrrev_b32 v7, 5, v1
    v_lshl_add_u32 v6, v7, 2, v6
    v_bfe_u32 v7, v1, 1, 2
    v_add_u32 v6, v6, v7
    v_mul_u32_u24 v6, 3584, v6
    v_and_b32 v7, 1, v1
    v_lshl_add_u32 v26, v7, 4, v6
    s_mul_i32 s14, s5, 224
    s_and_b32 s6, s5, 1
    s_lshl_b32 s7, s6, 5
    s_add_u32 s14, s14, s7
    s_mul_i32 s7, s3, 57344
    s_add_u32 s14, s14, s7
    s_mul_i32 s7, s6, 224
    s_sub_u32 s83, 192, s7
    s_and_b32 s6, s3, 1
    s_mul_i32 s6, s6, 57344
    s_sub_u32 s83, s83, s6
    s_add_u32 s6, s13, 0
    s_and_b32 s6, s6, 1023
    s_mul_i32 s6, s6, 1792
    s_add_u32 s80, s14, s6
    s_add_u32 s6, s13, 256
    s_and_b32 s6, s6, 1023
    s_mul_i32 s6, s6, 1792
    s_add_u32 s81, s14, s6
    s_add_u32 s6, s13, 512
    s_and_b32 s6, s6, 1023
    s_mul_i32 s6, s6, 1792
    s_add_u32 s86, s14, s6
    s_add_u32 s6, s13, 768
    s_and_b32 s6, s6, 1023
    s_mul_i32 s6, s6, 1792
    s_add_u32 s87, s14, s6
    s_lshl_b32 s101, s77, 4
    s_cmp_eq_u32 s77, 0
    s_cbranch_scc1 WOB
    s_setprio 3
    s_add_u32 m0, s85, 0
    s_nop 0
    buffer_load_dwordx4 v22, s[56:59], s9 offen lds
    s_add_u32 m0, s85, 1024
    s_nop 0
    buffer_load_dwordx4 v22, s[64:67], s9 offen lds
    s_setprio 0
WOB:
    s_barrier
    s_add_u32 s6, s13, 256
    s_and_b32 s6, s6, 1023
    s_add_u32 s10, s8, s6
    s_add_u32 m0, s85, 2048
    s_nop 0
    buffer_load_dwordx4 v120, s[48:51], s10 offen offset:0 lds
    buffer_load_dwordx4 v121, s[48:51], s10 offen offset:1024 lds
    buffer_load_dwordx4 v122, s[48:51], s10 offen offset:2048 lds
    buffer_load_dwordx4 v123, s[48:51], s10 offen offset:3072 lds
    s_add_u32 s6, s13, 256
    s_and_b32 s6, s6, 1023
    s_add_u32 s9, s11, s6
    s_add_u32 m0, s85, 6144
    s_nop 0
    buffer_load_dwordx4 v22, s[56:59], s9 offen lds
    s_add_u32 m0, s85, 7168
    s_nop 0
    buffer_load_dwordx4 v22, s[64:67], s9 offen lds
    s_waitcnt vmcnt(6) lgkmcnt(0)
    s_barrier
    ds_read_b128 v[128:131], v10 offset:14336
    ds_read_b128 v[132:135], v11 offset:14336
    ds_read_b128 v[136:139], v12 offset:14336
    ds_read_b128 v[140:143], v13 offset:14336
    ds_read_b128 v[64:67], v14 offset:0
    ds_read_b128 v[192:195], v18 offset:14336
    ds_read_b128 v[80:83], v14 offset:1024
    ds_read_b128 v[68:71], v15 offset:0
    s_waitcnt lgkmcnt(7)
    v_mfma_f32_16x16x32_bf16 v[32:35], v[128:131], v[128:131], 0
    ds_read_b128 v[196:199], v19 offset:14336
    v_mfma_f32_16x16x32_bf16 v[36:39], v[56:59], v[128:131], 0
    ds_read_b128 v[84:87], v15 offset:1024
    s_waitcnt lgkmcnt(8)
    v_mfma_f32_16x16x32_bf16 v[32:35], v[132:135], v[132:135], v[32:35]
    ds_read_b128 v[72:75], v16 offset:0
    v_mfma_f32_16x16x32_bf16 v[36:39], v[56:59], v[132:135], v[36:39]
    ds_read_b128 v[200:203], v20 offset:14336
    s_waitcnt lgkmcnt(9)
    v_mfma_f32_16x16x32_bf16 v[32:35], v[136:139], v[136:139], v[32:35]
    ds_read_b128 v[88:91], v16 offset:1024
    v_mfma_f32_16x16x32_bf16 v[36:39], v[56:59], v[136:139], v[36:39]
    ds_read_b128 v[76:79], v17 offset:0
    s_waitcnt lgkmcnt(10)
    v_mfma_f32_16x16x32_bf16 v[32:35], v[140:143], v[140:143], v[32:35]
    ds_read_b128 v[204:207], v21 offset:14336
    v_mfma_f32_16x16x32_bf16 v[36:39], v[56:59], v[140:143], v[36:39]
    ds_read_b128 v[92:95], v17 offset:1024
    s_waitcnt lgkmcnt(9)
    v_mfma_f32_16x16x32_bf16 v[112:115], v[56:59], v[64:67], 0
    v_mfma_f32_16x16x32_bf16 v[96:99], v[128:131], v[64:67], 0
    v_mfma_f32_16x16x32_bf16 v[100:103], v[192:195], v[64:67], 0
    v_mfma_f32_16x16x32_bf16 v[116:119], v[56:59], v[80:83], 0
    v_mfma_f32_16x16x32_bf16 v[104:107], v[128:131], v[80:83], 0
    s_add_u32 s6, s13, 512
    s_and_b32 s6, s6, 1023
    s_add_u32 s10, s8, s6
    s_add_u32 m0, s85, 8192
    s_nop 0
    buffer_load_dwordx4 v120, s[48:51], s10 offen offset:0 lds
    buffer_load_dwordx4 v121, s[48:51], s10 offen offset:1024 lds
    v_mfma_f32_16x16x32_bf16 v[108:111], v[192:195], v[80:83], 0
    s_waitcnt lgkmcnt(6)
    v_mfma_f32_16x16x32_bf16 v[96:99], v[132:135], v[68:71], v[96:99]
    v_mfma_f32_16x16x32_bf16 v[100:103], v[196:199], v[68:71], v[100:103]
    buffer_load_dwordx4 v122, s[48:51], s10 offen offset:2048 lds
    buffer_load_dwordx4 v123, s[48:51], s10 offen offset:3072 lds
    v_mfma_f32_16x16x32_bf16 v[104:107], v[132:135], v[84:87], v[104:107]
    v_mfma_f32_16x16x32_bf16 v[108:111], v[196:199], v[84:87], v[108:111]
    s_add_u32 s6, s13, 512
    s_and_b32 s6, s6, 1023
    s_add_u32 s9, s11, s6
    s_add_u32 m0, s85, 12288
    s_nop 0
    buffer_load_dwordx4 v22, s[56:59], s9 offen lds
    s_waitcnt lgkmcnt(3)
    v_mfma_f32_16x16x32_bf16 v[96:99], v[136:139], v[72:75], v[96:99]
    v_mfma_f32_16x16x32_bf16 v[100:103], v[200:203], v[72:75], v[100:103]
    v_mfma_f32_16x16x32_bf16 v[104:107], v[136:139], v[88:91], v[104:107]
    s_add_u32 m0, s85, 13312
    s_nop 0
    buffer_load_dwordx4 v22, s[64:67], s9 offen lds
    v_mfma_f32_16x16x32_bf16 v[108:111], v[200:203], v[88:91], v[108:111]
    s_waitcnt lgkmcnt(0)
    v_mfma_f32_16x16x32_bf16 v[96:99], v[140:143], v[76:79], v[96:99]
    v_mfma_f32_16x16x32_bf16 v[100:103], v[204:207], v[76:79], v[100:103]
    s_add_u32 s6, s13, 768
    s_and_b32 s6, s6, 1023
    s_add_u32 s9, s11, s6
    s_add_u32 m0, s85, 18432
    s_nop 0
    buffer_load_dwordx4 v22, s[56:59], s9 offen lds
    v_mfma_f32_16x16x32_bf16 v[104:107], v[140:143], v[92:95], v[104:107]
    v_mfma_f32_16x16x32_bf16 v[108:111], v[204:207], v[92:95], v[108:111]
    s_add_u32 m0, s85, 19456
    s_nop 0
    buffer_load_dwordx4 v22, s[64:67], s9 offen lds
    s_waitcnt vmcnt(8) lgkmcnt(0)
    s_barrier
    ds_read_b128 v[144:147], v10 offset:2048
    ds_read_b128 v[148:151], v11 offset:2048
    ds_read_b128 v[152:155], v12 offset:2048
    ds_read_b128 v[156:159], v13 offset:2048
    ds_read_b128 v[64:67], v14 offset:6144
    ds_read_b128 v[208:211], v18 offset:2048
    ds_read_b128 v[80:83], v14 offset:7168
    ds_read_b128 v[68:71], v15 offset:6144
    s_waitcnt lgkmcnt(7)
    v_mfma_f32_16x16x32_bf16 v[32:35], v[144:147], v[144:147], v[32:35]
    ds_read_b128 v[212:215], v19 offset:2048
    v_mfma_f32_16x16x32_bf16 v[36:39], v[56:59], v[144:147], v[36:39]
    ds_read_b128 v[84:87], v15 offset:7168
    s_waitcnt lgkmcnt(8)
    v_mfma_f32_16x16x32_bf16 v[32:35], v[148:151], v[148:151], v[32:35]
    ds_read_b128 v[72:75], v16 offset:6144
    v_mfma_f32_16x16x32_bf16 v[36:39], v[56:59], v[148:151], v[36:39]
    ds_read_b128 v[216:219], v20 offset:2048
    s_waitcnt lgkmcnt(9)
    v_mfma_f32_16x16x32_bf16 v[32:35], v[152:155], v[152:155], v[32:35]
    ds_read_b128 v[88:91], v16 offset:7168
    v_mfma_f32_16x16x32_bf16 v[36:39], v[56:59], v[152:155], v[36:39]
    ds_read_b128 v[76:79], v17 offset:6144
    s_waitcnt lgkmcnt(10)
    v_mfma_f32_16x16x32_bf16 v[32:35], v[156:159], v[156:159], v[32:35]
    ds_read_b128 v[220:223], v21 offset:2048
    v_mfma_f32_16x16x32_bf16 v[36:39], v[56:59], v[156:159], v[36:39]
    ds_read_b128 v[92:95], v17 offset:7168
    s_waitcnt lgkmcnt(9)
    v_mfma_f32_16x16x32_bf16 v[112:115], v[56:59], v[64:67], v[112:115]
    v_lshlrev_b32 v4, 16, v62
    v_mfma_f32_16x16x32_bf16 v[96:99], v[144:147], v[64:67], v[96:99]
    v_lshlrev_b32 v60, 16, v60
    v_mfma_f32_16x16x32_bf16 v[100:103], v[208:211], v[64:67], v[100:103]
    v_lshlrev_b32 v61, 16, v61
    v_mul_f32 v4, 0x3fb8aa3b, v4
    v_mfma_f32_16x16x32_bf16 v[116:119], v[56:59], v[80:83], v[116:119]
    v_exp_f32 v4, v4
    v_mfma_f32_16x16x32_bf16 v[104:107], v[144:147], v[80:83], v[104:107]
    v_cvt_pk_bf16_f32 v4, 0, v4
    v_mul_f32 v62, v4, v60
    v_mfma_f32_16x16x32_bf16 v[108:111], v[208:211], v[80:83], v[108:111]
    v_mul_f32 v63, v4, v61
    s_lshl_b32 s6, s4, 2
    v_mov_b32 v6, s6
    v_mov_b32 v7, 1
    s_or_b32 s6, s3, s5
    s_cmp_eq_u32 s6, 0
    s_cselect_b32 exec_lo, 1, 0
    s_mov_b32 exec_hi, 0
    global_store_dword v6, v7, s[42:43] sc1
    s_mov_b64 exec, -1
    s_waitcnt lgkmcnt(6)
    v_mfma_f32_16x16x32_bf16 v[96:99], v[148:151], v[68:71], v[96:99]
    v_mul_f32 v62, 0x3fb8aa3b, v62
    v_mul_f32 v63, 0.15915494309189535, v63
    v_mfma_f32_16x16x32_bf16 v[100:103], v[212:215], v[68:71], v[100:103]
    v_exp_f32 v4, v62
    v_mfma_f32_16x16x32_bf16 v[104:107], v[148:151], v[84:87], v[104:107]
    v_fract_f32 v5, v63
    v_cos_f32 v48, v5
    v_mfma_f32_16x16x32_bf16 v[108:111], v[212:215], v[84:87], v[108:111]
    v_sin_f32 v50, v5
    s_add_u32 s6, s13, 768
    s_and_b32 s6, s6, 1023
    s_add_u32 s10, s8, s6
    s_add_u32 m0, s85, 14336
    s_nop 0
    buffer_load_dwordx4 v120, s[48:51], s10 offen offset:0 lds
    buffer_load_dwordx4 v121, s[48:51], s10 offen offset:1024 lds
    s_waitcnt lgkmcnt(3)
    v_mfma_f32_16x16x32_bf16 v[96:99], v[152:155], v[72:75], v[96:99]
    v_mul_f32 v48, v48, v4
    v_mfma_f32_16x16x32_bf16 v[100:103], v[216:219], v[72:75], v[100:103]
    v_mul_f32 v50, v50, v4
    v_add_f32 v4, -1.0, v48
    v_mfma_f32_16x16x32_bf16 v[104:107], v[152:155], v[88:91], v[104:107]
    v_mul_f32 v5, v60, v60
    v_mfma_f32_16x16x32_bf16 v[108:111], v[216:219], v[88:91], v[108:111]
    v_fmac_f32 v5, v61, v61
    v_rcp_f32 v5, v5
    buffer_load_dwordx4 v122, s[48:51], s10 offen offset:2048 lds
    buffer_load_dwordx4 v123, s[48:51], s10 offen offset:3072 lds
    s_waitcnt lgkmcnt(0)
    v_mfma_f32_16x16x32_bf16 v[96:99], v[156:159], v[76:79], v[96:99]
    v_mul_f32 v28, v4, v60
    v_mfma_f32_16x16x32_bf16 v[100:103], v[220:223], v[76:79], v[100:103]
    v_fmac_f32 v28, v50, v61
    v_mul_f32 v30, v50, v60
    v_mfma_f32_16x16x32_bf16 v[104:107], v[156:159], v[92:95], v[104:107]
    v_fma_f32 v30, -v4, v61, v30
    v_mfma_f32_16x16x32_bf16 v[108:111], v[220:223], v[92:95], v[108:111]
    v_mul_f32 v28, v28, v5
    v_mul_f32 v30, v30, v5
    s_add_u32 m0, s85, 1024
    s_add_u32 s10, s80, 0
    buffer_load_dwordx4 v23, s[52:55], s10 offen lds
    s_mov_b32 s68, s38
    s_mov_b32 s69, s39
    s_mov_b32 s70, 1835008
    s_mov_b32 s71, 0x20000
    s_mov_b32 s72, s40
    s_mov_b32 s73, s41
    s_mov_b32 s74, 4194304
    s_mov_b32 s75, 0x20000
    s_and_b32 s6, s100, 3
    s_mul_i32 s7, s6, 1
    s_add_u32 s7, s7, s79
    s_and_b32 s97, s7, 7
    s_bitcmp1_b32 s97, 0
    s_cselect_b32 s16, s28, s26
    s_cselect_b32 s17, s29, s27
    s_cselect_b32 s20, s26, s28
    s_cselect_b32 s21, s27, s29
    s_mov_b32 s18, 524288
    s_mov_b32 s19, 0x20000
    s_mov_b32 s22, 524288
    s_mov_b32 s23, 0x20000
    s_add_u32 s15, s6, s79
    s_waitcnt vmcnt(7) lgkmcnt(0)
    s_barrier
    ds_read_b128 v[160:163], v10 offset:8192
    ds_read_b128 v[164:167], v11 offset:8192
    ds_read_b128 v[168:171], v12 offset:8192
    ds_read_b128 v[172:175], v13 offset:8192
    ds_read_b128 v[64:67], v14 offset:12288
    ds_read_b128 v[224:227], v18 offset:8192
    ds_read_b128 v[80:83], v14 offset:13312
    ds_read_b128 v[68:71], v15 offset:12288
    s_waitcnt lgkmcnt(7)
    v_mfma_f32_16x16x32_bf16 v[32:35], v[160:163], v[160:163], v[32:35]
    ds_read_b128 v[228:231], v19 offset:8192
    v_mfma_f32_16x16x32_bf16 v[36:39], v[56:59], v[160:163], v[36:39]
    ds_read_b128 v[84:87], v15 offset:13312
    s_waitcnt lgkmcnt(8)
    v_mfma_f32_16x16x32_bf16 v[32:35], v[164:167], v[164:167], v[32:35]
    ds_read_b128 v[72:75], v16 offset:12288
    v_mfma_f32_16x16x32_bf16 v[36:39], v[56:59], v[164:167], v[36:39]
    ds_read_b128 v[232:235], v20 offset:8192
    s_waitcnt lgkmcnt(9)
    v_mfma_f32_16x16x32_bf16 v[32:35], v[168:171], v[168:171], v[32:35]
    ds_read_b128 v[88:91], v16 offset:13312
    v_mfma_f32_16x16x32_bf16 v[36:39], v[56:59], v[168:171], v[36:39]
    ds_read_b128 v[76:79], v17 offset:12288
    s_waitcnt lgkmcnt(10)
    v_mfma_f32_16x16x32_bf16 v[32:35], v[172:175], v[172:175], v[32:35]
    ds_read_b128 v[236:239], v21 offset:8192
    v_mfma_f32_16x16x32_bf16 v[36:39], v[56:59], v[172:175], v[36:39]
    ds_read_b128 v[92:95], v17 offset:13312
    s_waitcnt lgkmcnt(9)
    v_mfma_f32_16x16x32_bf16 v[112:115], v[56:59], v[64:67], v[112:115]
    v_mul_f32 v4, 4.0, v62
    v_mfma_f32_16x16x32_bf16 v[96:99], v[160:163], v[64:67], v[96:99]
    v_mul_f32 v5, 4.0, v63
    v_exp_f32 v4, v4
    v_mfma_f32_16x16x32_bf16 v[100:103], v[224:227], v[64:67], v[100:103]
    v_fract_f32 v5, v5
    v_cos_f32 v24, v5
    v_mfma_f32_16x16x32_bf16 v[116:119], v[56:59], v[80:83], v[116:119]
    v_sin_f32 v25, v5
    v_mul_f32 v24, v24, v4
    v_mfma_f32_16x16x32_bf16 v[104:107], v[160:163], v[80:83], v[104:107]
    v_mul_f32 v25, v25, v4
    v_mul_f32 v4, v25, v25
    s_add_u32 m0, s85, 2048
    s_add_u32 s10, s81, 0
    buffer_load_dwordx4 v23, s[52:55], s10 offen lds
    v_mfma_f32_16x16x32_bf16 v[108:111], v[224:227], v[80:83], v[108:111]
    v_add_f32 v5, v24, v24
    v_fma_f32 v40, v24, v24, -v4
    s_waitcnt lgkmcnt(6)
    v_mfma_f32_16x16x32_bf16 v[96:99], v[164:167], v[68:71], v[96:99]
    v_mul_f32 v41, v5, v25
    v_mfma_f32_16x16x32_bf16 v[100:103], v[228:231], v[68:71], v[100:103]
    v_mul_f32 v4, v41, v41
    v_add_f32 v5, v40, v40
    s_add_u32 m0, s85, 3072
    s_add_u32 s10, s86, 0
    buffer_load_dwordx4 v23, s[52:55], s10 offen lds
    v_mfma_f32_16x16x32_bf16 v[104:107], v[164:167], v[84:87], v[104:107]
    v_fma_f32 v42, v40, v40, -v4
    v_mul_f32 v43, v5, v41
    v_mfma_f32_16x16x32_bf16 v[108:111], v[228:231], v[84:87], v[108:111]
    v_mul_f32 v4, v43, v43
    v_add_f32 v5, v42, v42
    s_add_u32 m0, s85, 4096
    s_add_u32 s10, s87, 0
    buffer_load_dwordx4 v23, s[52:55], s10 offen lds
    s_waitcnt lgkmcnt(3)
    v_mfma_f32_16x16x32_bf16 v[96:99], v[168:171], v[72:75], v[96:99]
    v_fma_f32 v44, v42, v42, -v4
    v_mul_f32 v45, v5, v43
    v_mfma_f32_16x16x32_bf16 v[100:103], v[232:235], v[72:75], v[100:103]
    v_lshlrev_b32 v8, 3, v3
    v_cvt_f32_u32 v8, v8
    v_mfma_f32_16x16x32_bf16 v[104:107], v[168:171], v[88:91], v[104:107]
    v_mul_f32 v4, v8, v62
    s_add_u32 m0, s85, 5120
    s_add_u32 s10, s80, 64
    buffer_load_dwordx4 v23, s[52:55], s10 offen lds
    v_mfma_f32_16x16x32_bf16 v[108:111], v[232:235], v[88:91], v[108:111]
    v_mul_f32 v5, v8, v63
    v_exp_f32 v4, v4
    s_waitcnt lgkmcnt(0)
    v_mfma_f32_16x16x32_bf16 v[96:99], v[172:175], v[76:79], v[96:99]
    v_fract_f32 v5, v5
    v_cos_f32 v46, v5
    v_mfma_f32_16x16x32_bf16 v[100:103], v[236:239], v[76:79], v[100:103]
    v_sin_f32 v47, v5
    v_mul_f32 v46, v46, v4
    s_add_u32 m0, s85, 6144
    s_add_u32 s10, s81, 64
    buffer_load_dwordx4 v23, s[52:55], s10 offen lds
    v_mfma_f32_16x16x32_bf16 v[104:107], v[172:175], v[92:95], v[104:107]
    v_mul_f32 v47, v47, v4
    v_mov_b32 v121, 0
    v_mfma_f32_16x16x32_bf16 v[108:111], v[236:239], v[92:95], v[108:111]
    v_mov_b32 v122, 0
    v_mov_b32 v123, 0
    s_add_u32 m0, s85, 7168
    s_add_u32 s10, s86, 64
    buffer_load_dwordx4 v23, s[52:55], s10 offen lds
    s_lshl_b32 s6, s79, 16
    s_lshl_b32 s7, s3, 7
    s_add_u32 s6, s6, s7
    s_lshl_b32 s7, s77, 15
    s_add_u32 s24, s6, s7
    s_xor_b32 s25, s24, 32768
    s_lshl_b32 s6, s4, 11
    s_add_u32 s6, s6, 13697024
    s_lshr_b32 s7, s5, 1
    s_lshl_b32 s7, s7, 8
    s_add_u32 s34, s6, s7
    s_lshr_b32 s7, s76, 1
    s_lshl_b32 s7, s7, 7
    s_add_u32 s34, s34, s7
    s_lshl_b32 s7, s3, 8
    s_add_u32 s6, s6, s7
    s_lshl_b32 s7, s78, 7
    s_add_u32 s35, s6, s7
    s_lshl_b32 s6, s4, 18
    s_add_u32 s6, s6, 8388608
    s_lshl_b32 s7, s78, 17
    s_add_u32 s7, s6, s7
    s_lshl_b32 s12, s3, 13
    s_add_u32 s26, s7, s12
    s_lshl_b32 s88, s97, 10
    s_lshl_b32 s7, s76, 16
    s_add_u32 s6, s6, s7
    s_lshl_b32 s7, s5, 12
    s_add_u32 s6, s6, s7
    s_lshl_b32 s7, s77, 11
    s_add_u32 s27, s6, s7
    s_lshl_b32 s6, s5, 8
    s_lshl_b32 s7, s77, 7
    s_add_u32 s6, s6, s7
    s_add_u32 s28, s6, 13631488
    s_mul_i32 s6, s3, 229376
    s_lshl_b32 s7, s79, 7
    s_add_u32 s12, s6, s7
    s_mul_i32 s6, s4, 112
    s_mul_i32 s7, s3, 14
    s_add_u32 s6, s6, s7
    s_lshl_b32 s6, s6, 12
    s_lshl_b32 s7, s78, 11
    s_add_u32 s96, s6, s7
    s_add_u32 s6, s15, 0
    s_and_b32 s7, s6, 1
    s_and_b32 s6, s6, 2
    s_lshl_b32 s6, s6, 2
    s_or_b32 s7, s7, s6
    s_lshl_b32 s6, s7, 12
    s_add_u32 s0, s96, s6
    s_lshl_b32 s6, s7, 14
    s_add_u32 s36, s12, s6
    s_add_u32 s6, s15, 1
    s_and_b32 s7, s6, 1
    s_and_b32 s6, s6, 2
    s_lshl_b32 s6, s6, 2
    s_or_b32 s7, s7, s6
    s_lshl_b32 s6, s7, 12
    s_add_u32 s1, s96, s6
    s_lshl_b32 s6, s7, 14
    s_add_u32 s37, s12, s6
    s_add_u32 s6, s15, 2
    s_and_b32 s7, s6, 1
    s_and_b32 s6, s6, 2
    s_lshl_b32 s6, s6, 2
    s_or_b32 s7, s7, s6
    s_lshl_b32 s6, s7, 12
    s_add_u32 s29, s96, s6
    s_lshl_b32 s6, s7, 14
    s_add_u32 s38, s12, s6
    s_add_u32 s6, s15, 3
    s_and_b32 s7, s6, 1
    s_and_b32 s6, s6, 2
    s_lshl_b32 s6, s6, 2
    s_or_b32 s7, s7, s6
    s_lshl_b32 s6, s7, 12
    s_add_u32 s30, s96, s6
    s_lshl_b32 s6, s7, 14
    s_add_u32 s39, s12, s6
    s_add_u32 s6, s15, 4
    s_and_b32 s7, s6, 1
    s_add_u32 s7, s7, 6
    s_lshl_b32 s6, s7, 12
    s_add_u32 s31, s96, s6
    s_lshl_b32 s6, s7, 14
    s_add_u32 s40, s12, s6
    s_add_u32 s6, s15, 5
    s_and_b32 s7, s6, 1
    s_add_u32 s7, s7, 6
    s_lshl_b32 s6, s7, 12
    s_add_u32 s89, s96, s6
    s_lshl_b32 s6, s7, 14
    s_add_u32 s41, s12, s6
    s_lshr_b32 s6, s79, 1
    s_and_b32 s7, s6, 1
    s_and_b32 s6, s6, 2
    s_lshl_b32 s6, s6, 2
    s_or_b32 s7, s7, s6
    s_lshl_b32 s7, s7, 12
    s_and_b32 s6, s79, 1
    s_lshl_b32 s6, s6, 10
    s_add_u32 s7, s7, s6
    s_add_u32 s14, s96, s7
    s_mov_b32 s96, 0
    v_lshrrev_b32 v6, 2, v2
    v_lshlrev_b32 v6, 3, v6
    v_and_b32 v7, 3, v2
    v_add_u32 v6, v6, v7
    v_and_b32 v7, 1, v3
    v_xor_b32 v7, s77, v7
    v_lshl_add_u32 v6, v7, 2, v6
    v_lshlrev_b32 v6, 4, v6
    v_lshrrev_b32 v7, 1, v3
    v_lshl_add_u32 v31, v7, 9, v6
    s_mul_i32 s82, s4, 112
    s_mul_i32 s6, s5, 7
    s_add_u32 s82, s82, s6
    s_and_b32 s6, s5, 1
    s_cmp_eq_u32 s6, 0
    s_cselect_b32 s7, 6, 0
    s_add_u32 s84, s82, s7
    s_add_u32 s82, s82, s6
    s_add_u32 s82, s82, s77
    s_lshl_b32 s82, s82, 12
    s_lshl_b32 s84, s84, 12
    s_lshl_b32 s6, s76, 10
    s_add_u32 s82, s82, s6
    s_add_u32 s84, s84, s6
    s_waitcnt vmcnt(7) lgkmcnt(0)
    s_barrier
    ds_read_b128 v[176:179], v10 offset:14336
    ds_read_b128 v[180:183], v11 offset:14336
    ds_read_b128 v[184:187], v12 offset:14336
    ds_read_b128 v[188:191], v13 offset:14336
    ds_read_b128 v[64:67], v14 offset:18432
    ds_read_b128 v[240:243], v18 offset:14336
    ds_read_b128 v[80:83], v14 offset:19456
    ds_read_b128 v[68:71], v15 offset:18432
    s_waitcnt lgkmcnt(7)
    v_mfma_f32_16x16x32_bf16 v[32:35], v[176:179], v[176:179], v[32:35]
    ds_read_b128 v[244:247], v19 offset:14336
    v_mfma_f32_16x16x32_bf16 v[36:39], v[56:59], v[176:179], v[36:39]
    ds_read_b128 v[84:87], v15 offset:19456
    s_waitcnt lgkmcnt(8)
    v_mfma_f32_16x16x32_bf16 v[32:35], v[180:183], v[180:183], v[32:35]
    ds_read_b128 v[72:75], v16 offset:18432
    v_mfma_f32_16x16x32_bf16 v[36:39], v[56:59], v[180:183], v[36:39]
    ds_read_b128 v[248:251], v20 offset:14336
    s_waitcnt lgkmcnt(9)
    v_mfma_f32_16x16x32_bf16 v[32:35], v[184:187], v[184:187], v[32:35]
    ds_read_b128 v[88:91], v16 offset:19456
    v_mfma_f32_16x16x32_bf16 v[36:39], v[56:59], v[184:187], v[36:39]
    ds_read_b128 v[76:79], v17 offset:18432
    s_waitcnt lgkmcnt(10)
    v_mfma_f32_16x16x32_bf16 v[32:35], v[188:191], v[188:191], v[32:35]
    ds_read_b128 v[252:255], v21 offset:14336
    v_mfma_f32_16x16x32_bf16 v[36:39], v[56:59], v[188:191], v[36:39]
    ds_read_b128 v[92:95], v17 offset:19456
    s_waitcnt lgkmcnt(9)
    v_mfma_f32_16x16x32_bf16 v[112:115], v[56:59], v[64:67], v[112:115]
    s_nop 2
    v_cndmask_b32 v4, v32, v33, s[90:91]
    v_cndmask_b32 v4, v4, v34, s[92:93]
    v_cndmask_b32 v4, v4, v35, s[94:95]
    v_mfma_f32_16x16x32_bf16 v[96:99], v[176:179], v[64:67], v[96:99]
    v_cndmask_b32 v4, 0, v4, s[46:47]
    v_mul_f32 v8, 0xbb000000, v36
    v_mov_b32 v5, v4
    v_mfma_f32_16x16x32_bf16 v[100:103], v[240:243], v[64:67], v[100:103]
    v_cvt_pk_bf16_f32 v52, v8, v8
    v_lshrrev_b32 v6, 2, v2
    v_permlane16_swap_b32 v4, v5
    v_mfma_f32_16x16x32_bf16 v[116:119], v[56:59], v[80:83], v[116:119]
    v_lshlrev_b32 v6, 3, v6
    v_add_f32 v4, v4, v5
    v_mov_b32 v5, v4
    v_and_b32 v7, 3, v2
    v_mfma_f32_16x16x32_bf16 v[104:107], v[176:179], v[80:83], v[104:107]
    v_add_u32 v6, v6, v7
    v_permlane32_swap_b32 v4, v5
    s_lshl_b32 s6, s76, 3
    s_add_u32 s6, s6, s77
    s_lshl_b32 s6, s6, 4
    v_lshl_add_u32 v9, v6, 2, s6
    s_add_u32 m0, s85, 8192
    s_add_u32 s10, s87, 64
    buffer_load_dwordx4 v23, s[52:55], s10 offen lds
    v_mfma_f32_16x16x32_bf16 v[108:111], v[240:243], v[80:83], v[108:111]
    v_add_f32 v4, v4, v5
    v_mul_f32 v4, 0x3b000000, v4
    v_fma_f32 v4, -v8, v8, v4
    s_waitcnt lgkmcnt(6)
    v_mfma_f32_16x16x32_bf16 v[96:99], v[180:183], v[68:71], v[96:99]
    v_max_f32 v4, 0, v4
    v_cvt_pk_bf16_f32 v4, 0, v4
    v_add_f32 v4, 0x3727c5ac, v4
    v_mov_b32 v0, 1
    v_lshlrev_b32 v35, 2, v2
    s_cmp_eq_u32 s3, 0
    s_cselect_b64 exec, -1, 0
    global_load_dword v0, v35, s[42:43] sc1
    s_mov_b64 exec, -1
    v_mfma_f32_16x16x32_bf16 v[100:103], v[244:247], v[68:71], v[100:103]
    v_cvt_pk_bf16_f32 v4, 0, v4
    v_sqrt_f32 v4, v4
    s_lshl_b32 s6, s76, 2
    s_lshl_b32 s7, s77, 1
    s_add_u32 s6, s6, s7
    v_lshl_add_u32 v12, v2, 4, s6
    v_cvt_pk_bf16_f32 v53, 0, v4
    v_mfma_f32_16x16x32_bf16 v[104:107], v[180:183], v[84:87], v[104:107]
    v_rcp_f32 v4, v53
    v_cvt_pk_bf16_f32 v5, v53, v8
    ds_write_b32 v9, v52 offset:20992
    s_add_u32 m0, s85, 9216
    s_add_u32 s10, s80, 128
    buffer_load_dwordx4 v23, s[52:55], s10 offen lds
    v_mfma_f32_16x16x32_bf16 v[108:111], v[244:247], v[84:87], v[108:111]
    ds_write_b32 v9, v53 offset:512
    ds_write_b32 v9, v4 offset:0
    ds_write_b32 v9, v5 offset:20480
    s_waitcnt lgkmcnt(7)
    v_mfma_f32_16x16x32_bf16 v[96:99], v[184:187], v[72:75], v[96:99]
    v_mul_f32 v60, 0xbfb8aa3b, v4
    v_cvt_pk_bf16_f32 v6, v112, v112
    v_cvt_pk_bf16_f32 v7, v116, v116
    ds_write_b16 v12, v6 offset:40960
    v_mfma_f32_16x16x32_bf16 v[100:103], v[248:251], v[72:75], v[100:103]
    ds_write_b16 v12, v7 offset:41216
    v_lshlrev_b32 v13, 4, v2
    v_lshl_add_u32 v13, v3, 2, v13
    s_add_u32 m0, s85, 10240
    s_add_u32 s10, s81, 128
    buffer_load_dwordx4 v23, s[52:55], s10 offen lds
    v_mfma_f32_16x16x32_bf16 v[104:107], v[184:187], v[88:91], v[104:107]
    v_mov_b32 v18, v44
    v_mov_b32 v20, v46
    v_mov_b32 v19, v45
    v_mfma_f32_16x16x32_bf16 v[108:111], v[248:251], v[88:91], v[108:111]
    v_mov_b32 v21, v47
    v_lshrrev_b32 v4, 1, v3
    v_mul_u32_u24 v4, 20480, v4
    s_add_u32 m0, s85, 11264
    s_add_u32 s10, s86, 128
    buffer_load_dwordx4 v23, s[52:55], s10 offen lds
    s_waitcnt lgkmcnt(6)
    v_mfma_f32_16x16x32_bf16 v[96:99], v[188:191], v[76:79], v[96:99]
    v_and_b32 v5, 1, v3
    v_lshl_add_u32 v4, v5, 9, v4
    v_xor_b32 v5, s77, v5
    v_lshl_add_u32 v4, v5, 5, v4
    v_mfma_f32_16x16x32_bf16 v[100:103], v[252:255], v[76:79], v[100:103]
    v_bfe_u32 v5, v1, 2, 2
    v_lshl_add_u32 v4, v5, 6, v4
    v_and_b32 v5, 3, v1
    s_add_u32 m0, s85, 12288
    s_add_u32 s10, s87, 128
    buffer_load_dwordx4 v23, s[52:55], s10 offen lds
    v_mfma_f32_16x16x32_bf16 v[104:107], v[188:191], v[92:95], v[104:107]
    v_lshl_add_u32 v4, v5, 3, v4
    s_xor_b32 s6, s76, 0
    s_mul_i32 s6, s6, 40960
    v_add_u32 v14, s6, v4
    s_xor_b32 s6, s76, 1
    s_mul_i32 s6, s6, 40960
    v_add_u32 v15, s6, v4
    v_mfma_f32_16x16x32_bf16 v[108:111], v[252:255], v[92:95], v[108:111]
    s_xor_b32 s6, s76, 2
    s_mul_i32 s6, s6, 40960
    v_add_u32 v16, s6, v4
    s_xor_b32 s6, s76, 3
    s_mul_i32 s6, s6, 40960
    v_add_u32 v17, s6, v4
    v_xor_b32 v9, 16, v9
    s_lshl_b32 s6, s76, 7
    v_lshl_add_u32 v8, v3, 5, s6
    s_add_u32 m0, s85, 13312
    s_bitcmp1_b32 s3, 0
    s_cselect_b32 s10, s81, s80
    s_add_u32 s10, s10, s83
    buffer_load_dwordx4 v26, s[52:55], s10 offen lds
    s_waitcnt vmcnt(9) lgkmcnt(0)
    s_barrier
    s_add_u32 m0, s85, 14336
    s_bitcmp1_b32 s3, 0
    s_cselect_b32 s10, s87, s86
    s_add_u32 s10, s10, s83
    buffer_load_dwordx4 v26, s[52:55], s10 offen lds
    ds_read_b32 v120, v13 offset:40960
    ds_read_b32 v124, v13 offset:41216
    ds_read_b32 v54, v9 offset:20992
    ds_read_b32 v55, v9 offset:512
    ds_read_b64_tr_b16 v[64:65], v14 offset:1024
    ds_read_b64_tr_b16 v[66:67], v14 offset:1280
    ds_read_b64_tr_b16 v[68:69], v14 offset:2048
    ds_read_b64_tr_b16 v[70:71], v14 offset:2304
    ds_read_b128 v[112:115], v8 offset:0
    ds_read_b128 v[116:119], v8 offset:16
    ds_read_b32 v61, v9 offset:0
    ds_read_b64_tr_b16 v[72:73], v14 offset:3072
    ds_read_b64_tr_b16 v[74:75], v14 offset:3328
    s_waitcnt lgkmcnt(9)
    v_bfe_u32 v120, v120, s101, 16
    v_bfe_u32 v124, v124, s101, 16
    ds_read_b64_tr_b16 v[76:77], v14 offset:4096
    ds_read_b64_tr_b16 v[78:79], v14 offset:4352
    v_mfma_f32_16x16x32_bf16 v[96:99], v[52:55], v[120:123], v[96:99]
    ds_read_b64_tr_b16 v[80:81], v15 offset:1024
    ds_read_b64_tr_b16 v[82:83], v15 offset:1280
    v_mfma_f32_16x16x32_bf16 v[100:103], v[54:57], v[120:123], v[100:103]
    ds_read_b64_tr_b16 v[84:85], v15 offset:2048
    ds_read_b64_tr_b16 v[86:87], v15 offset:2304
    v_mfma_f32_16x16x32_bf16 v[104:107], v[52:55], v[124:127], v[104:107]
    ds_read_b64_tr_b16 v[88:89], v15 offset:3072
    ds_read_b64_tr_b16 v[90:91], v15 offset:3328
    v_mfma_f32_16x16x32_bf16 v[108:111], v[54:57], v[124:127], v[108:111]
    ds_read_b64_tr_b16 v[92:93], v15 offset:4096
    ds_read_b64_tr_b16 v[94:95], v15 offset:4352
    s_waitcnt lgkmcnt(15)
    v_mfma_f32_16x16x32_bf16 v[120:123], v[56:59], v[64:67], 0
    v_and_b32 v4, 7, v1
    v_lshrrev_b32 v5, 3, v1
    v_lshlrev_b32 v5, 10, v5
    v_lshlrev_b32 v7, 1, v3
    v_mfma_f32_16x16x32_bf16 v[32:35], v[64:67], v[128:131], 0
    v_xor_b32 v7, v7, v4
    v_lshl_add_u32 v10, v7, 4, v5
    v_xor_b32 v11, 16, v10
    v_mfma_f32_16x16x32_bf16 v[36:39], v[64:67], v[192:195], 0
    v_and_b32 v7, 1, v3
    v_lshlrev_b32 v7, 2, v7
    v_xor_b32 v7, v7, v4
    ds_read_b64_tr_b16 v[64:65], v16 offset:1024
    ds_read_b64_tr_b16 v[66:67], v16 offset:1280
    v_mfma_f32_16x16x32_bf16 v[120:123], v[56:59], v[68:71], v[120:123]
    v_lshl_add_u32 v27, v7, 4, v5
    s_waitcnt lgkmcnt(14)
    s_add_u32 m0, s85, 15360
    s_add_u32 s10, s24, 0
    buffer_load_dwordx4 v10, s[16:19], s10 offen sc1 lds
    v_mfma_f32_16x16x32_bf16 v[32:35], v[68:71], v[144:147], v[32:35]
    s_cmp_eq_u32 s77, 0
    s_cbranch_scc1 NOSWAP
    v_swap_b32 v96, v100
    v_swap_b32 v97, v101
    v_swap_b32 v98, v102
    v_swap_b32 v99, v103
    v_swap_b32 v104, v108
    v_swap_b32 v105, v109
    v_swap_b32 v106, v110
    v_swap_b32 v107, v111
NOSWAP:
    s_nop 1
    v_mul_f32 v96, v96, v112
    v_mul_f32 v104, v104, v112
    v_mfma_f32_16x16x32_bf16 v[36:39], v[68:71], v[208:211], v[36:39]
    v_mul_f32 v97, v97, v113
    v_mul_f32 v105, v105, v113
    v_mul_f32 v98, v98, v114
    v_mul_f32 v106, v106, v114
    ds_read_b64_tr_b16 v[68:69], v16 offset:2048
    ds_read_b64_tr_b16 v[70:71], v16 offset:2304
    s_waitcnt lgkmcnt(14)
    v_mfma_f32_16x16x32_bf16 v[120:123], v[56:59], v[72:75], v[120:123]
    v_mul_f32 v99, v99, v115
    v_mul_f32 v107, v107, v115
    v_mul_f32 v100, v100, v116
    v_mfma_f32_16x16x32_bf16 v[32:35], v[72:75], v[160:163], v[32:35]
    v_mul_f32 v108, v108, v116
    v_mul_f32 v101, v101, v117
    v_mul_f32 v109, v109, v117
    v_mfma_f32_16x16x32_bf16 v[36:39], v[72:75], v[224:227], v[36:39]
    s_add_u32 m0, s85, 16384
    s_add_u32 s10, s24, 8192
    buffer_load_dwordx4 v11, s[16:19], s10 offen sc1 lds
    v_mul_f32 v102, v102, v118
    v_mul_f32 v110, v110, v118
    ds_read_b64_tr_b16 v[72:73], v16 offset:3072
    ds_read_b64_tr_b16 v[74:75], v16 offset:3328
    s_waitcnt lgkmcnt(14)
    v_mfma_f32_16x16x32_bf16 v[120:123], v[56:59], v[76:79], v[120:123]
    v_mul_f32 v103, v103, v119
    v_mul_f32 v111, v111, v119
    v_mul_f32 v61, 0xbfb8aa3b, v61
    v_mfma_f32_16x16x32_bf16 v[32:35], v[76:79], v[176:179], v[32:35]
    v_fma_f32 v4, v48, v96, v97
    v_fma_f32 v8, v48, v100, v101
    v_fma_f32 v5, v48, v104, v105
    v_mfma_f32_16x16x32_bf16 v[36:39], v[76:79], v[240:243], v[36:39]
    v_fma_f32 v9, v48, v108, v109
    v_fma_f32 v4, -v50, v104, v4
    v_fma_f32 v8, -v50, v108, v8
    v_fmac_f32 v5, v50, v96
    ds_read_b64_tr_b16 v[76:77], v16 offset:4096
    ds_read_b64_tr_b16 v[78:79], v16 offset:4352
    s_waitcnt lgkmcnt(14)
    v_mfma_f32_16x16x32_bf16 v[32:35], v[80:83], v[132:135], v[32:35]
    v_fmac_f32 v9, v50, v100
    v_fma_f32 v6, v48, v4, v98
    v_fma_f32 v112, v48, v8, v102
    v_mfma_f32_16x16x32_bf16 v[36:39], v[80:83], v[196:199], v[36:39]
    v_fma_f32 v7, v48, v5, v106
    s_add_u32 m0, s85, 17408
    s_add_u32 s10, s24, 16384
    buffer_load_dwordx4 v10, s[16:19], s10 offen sc1 lds
    v_fma_f32 v113, v48, v9, v110
    ds_read_b64_tr_b16 v[80:81], v17 offset:1024
    ds_read_b64_tr_b16 v[82:83], v17 offset:1280
    s_waitcnt lgkmcnt(14)
    v_mfma_f32_16x16x32_bf16 v[32:35], v[84:87], v[148:151], v[32:35]
    v_fma_f32 v6, -v50, v5, v6
    v_fma_f32 v112, -v50, v9, v112
    v_fmac_f32 v7, v50, v4
    v_mfma_f32_16x16x32_bf16 v[36:39], v[84:87], v[212:215], v[36:39]
    v_fmac_f32 v113, v50, v8
    v_fma_f32 v49, v48, v6, v99
    v_fma_f32 v114, v48, v112, v103
    ds_read_b64_tr_b16 v[84:85], v17 offset:2048
    ds_read_b64_tr_b16 v[86:87], v17 offset:2304
    v_cvt_pk_bf16_f32 v121, v120, v120
    ds_write_b16 v12, v121 offset:41472
    s_waitcnt lgkmcnt(15)
    v_mfma_f32_16x16x32_bf16 v[32:35], v[88:91], v[164:167], v[32:35]
    v_fma_f32 v51, v48, v7, v107
    v_fma_f32 v115, v48, v113, v111
    v_fma_f32 v49, -v50, v7, v49
    v_fma_f32 v114, -v50, v113, v114
    v_mfma_f32_16x16x32_bf16 v[36:39], v[88:91], v[228:231], v[36:39]
    v_fmac_f32 v51, v50, v6
    v_fmac_f32 v115, v50, v112
    v_fmac_f32 v114, v24, v49
    ds_read_b64_tr_b16 v[88:89], v17 offset:3072
    ds_read_b64_tr_b16 v[90:91], v17 offset:3328
    s_waitcnt lgkmcnt(15)
    v_mfma_f32_16x16x32_bf16 v[32:35], v[92:95], v[180:183], v[32:35]
    v_fmac_f32 v115, v24, v51
    v_fma_f32 v114, -v25, v51, v114
    s_add_u32 m0, s85, 18432
    s_add_u32 s10, s24, 24576
    buffer_load_dwordx4 v11, s[16:19], s10 offen sc1 lds
    v_mfma_f32_16x16x32_bf16 v[36:39], v[92:95], v[244:247], v[36:39]
    v_fmac_f32 v115, v25, v49
    v_mov_b32 v116, v114
    v_mov_b32 v117, v115
    ds_read_b64_tr_b16 v[92:93], v17 offset:4096
    ds_read_b64_tr_b16 v[94:95], v17 offset:4352
    s_waitcnt lgkmcnt(15)
    v_mfma_f32_16x16x32_bf16 v[32:35], v[64:67], v[136:139], v[32:35]
    s_lshl_b32 s6, s77, 9
    s_add_u32 s6, s6, 81920
    v_lshl_add_u32 v4, v2, 5, s6
    s_lshl_b32 s6, s76, 3
    v_add_u32 v5, s6, v4
    v_permlane16_swap_b32 v114, v116
    v_mfma_f32_16x16x32_bf16 v[36:39], v[64:67], v[200:203], v[36:39]
    v_permlane16_swap_b32 v115, v117
    v_fmac_f32 v116, v40, v114
    v_fmac_f32 v117, v40, v115
    s_waitcnt lgkmcnt(13)
    v_mfma_f32_16x16x32_bf16 v[32:35], v[68:71], v[152:155], v[32:35]
    v_fma_f32 v116, -v41, v115, v116
    v_fmac_f32 v117, v41, v114
    v_mov_b32 v118, v116
    v_mov_b32 v119, v117
    v_mfma_f32_16x16x32_bf16 v[36:39], v[68:71], v[216:219], v[36:39]
    v_lshlrev_b32 v6, 3, v2
    s_nop 0
    v_permlane32_swap_b32 v116, v118
    s_waitcnt lgkmcnt(11)
    v_mfma_f32_16x16x32_bf16 v[32:35], v[72:75], v[168:171], v[32:35]
    v_permlane32_swap_b32 v117, v119
    v_fmac_f32 v118, v42, v116
    v_fmac_f32 v119, v42, v117
    v_mfma_f32_16x16x32_bf16 v[36:39], v[72:75], v[232:235], v[36:39]
    v_fma_f32 v118, -v43, v117, v118
    v_fmac_f32 v119, v43, v116
    ds_write_b64 v5, v[118:119]
    s_waitcnt lgkmcnt(10)
    v_mfma_f32_16x16x32_bf16 v[32:35], v[76:79], v[184:187], v[32:35]
    s_mov_b32 vcc_lo, 0
    s_mov_b32 vcc_hi, -1
    v_cndmask_b32 v116, 0, v116, vcc
    v_cndmask_b32 v117, 0, v117, vcc
    v_fmac_f32 v114, v40, v116
    v_fmac_f32 v115, v40, v117
    v_mfma_f32_16x16x32_bf16 v[36:39], v[76:79], v[248:251], v[36:39]
    v_fma_f32 v114, -v41, v117, v114
    v_fmac_f32 v115, v41, v116
    s_mov_b32 vcc_lo, 0xffff0000
    s_mov_b32 vcc_hi, 0xffff0000
    v_cndmask_b32 v22, v116, v114, vcc
    v_cndmask_b32 v23, v117, v115, vcc
    s_waitcnt vmcnt(10)
    s_mov_b32 s15, 0
RDYL:
    v_cmp_ne_u32 vcc, 1, v0
    s_nop 0
    s_cmp_eq_u64 vcc, 0
    s_cbranch_scc1 RDYOK
    s_add_u32 s15, s15, 1
    s_cmp_gt_u32 s15, 0x8000
    s_cbranch_scc1 RDYOK
    s_sleep 1
    v_lshlrev_b32 v7, 2, v2
    global_load_dword v0, v7, s[42:43] sc1
    s_waitcnt vmcnt(0)
    s_branch RDYL
RDYOK:
    s_waitcnt lgkmcnt(0)
    s_barrier
    ds_read_b32 v124, v13 offset:41472
    v_mfma_f32_16x16x32_bf16 v[32:35], v[80:83], v[140:143], v[32:35]
    v_mfma_f32_16x16x32_bf16 v[36:39], v[80:83], v[204:207], v[36:39]
    ds_read_b128 v[112:115], v4
    ds_read_b128 v[116:119], v4 offset:16
    s_add_u32 m0, s85, 1024
    s_add_u32 s10, s25, 0
    buffer_load_dwordx4 v10, s[16:19], s10 offen sc1 lds
    s_add_u32 m0, s85, 2048
    s_add_u32 s10, s25, 8192
    buffer_load_dwordx4 v11, s[16:19], s10 offen sc1 lds
    ds_read_b64_tr_b16 v[64:65], v14 offset:5120
    ds_read_b64_tr_b16 v[66:67], v14 offset:5376
    ds_read_b64_tr_b16 v[80:81], v15 offset:5120
    ds_read_b64_tr_b16 v[82:83], v15 offset:5376
    v_mfma_f32_16x16x32_bf16 v[32:35], v[84:87], v[156:159], v[32:35]
    s_waitcnt lgkmcnt(4)
    v_fmac_f32 v114, v18, v112
    v_fmac_f32 v115, v18, v113
    v_mfma_f32_16x16x32_bf16 v[36:39], v[84:87], v[220:223], v[36:39]
    v_fma_f32 v114, -v19, v113, v114
    v_fmac_f32 v115, v19, v112
    v_fmac_f32 v116, v18, v114
    ds_read_b64_tr_b16 v[68:69], v14 offset:6144
    ds_read_b64_tr_b16 v[70:71], v14 offset:6400
    ds_read_b64_tr_b16 v[84:85], v15 offset:6144
    ds_read_b64_tr_b16 v[86:87], v15 offset:6400
    v_mfma_f32_16x16x32_bf16 v[32:35], v[88:91], v[172:175], v[32:35]
    v_fmac_f32 v117, v18, v115
    v_fma_f32 v116, -v19, v115, v116
    v_fmac_f32 v117, v19, v114
    v_mfma_f32_16x16x32_bf16 v[36:39], v[88:91], v[236:239], v[36:39]
    v_fmac_f32 v118, v18, v116
    v_fmac_f32 v119, v18, v117
    v_fma_f32 v118, -v19, v117, v118
    v_fmac_f32 v119, v19, v116
    ds_read_b64_tr_b16 v[72:73], v14 offset:7168
    ds_read_b64_tr_b16 v[74:75], v14 offset:7424
    ds_read_b64_tr_b16 v[88:89], v15 offset:7168
    ds_read_b64_tr_b16 v[90:91], v15 offset:7424
    v_bfe_u32 v124, v124, s101, 16
    v_mfma_f32_16x16x32_bf16 v[32:35], v[92:95], v[188:191], v[32:35]
    v_or_b32 v118, 1, v118
    s_lshl_b32 s6, s4, 12
    s_add_u32 s6, s6, s28
    s_cmp_eq_u32 s76, 3
    s_cselect_b32 exec_lo, 0xffff, 0
    s_mov_b32 exec_hi, 0
    buffer_store_dwordx2 v[118:119], v6, s[60:63], s6 offen sc1
    s_mov_b64 exec, -1
    s_cmp_ge_u32 s76, 2
    s_cselect_b64 vcc, -1, 0
    v_cndmask_b32 v112, v112, v114, vcc
    v_cndmask_b32 v113, v113, v115, vcc
    v_mfma_f32_16x16x32_bf16 v[36:39], v[92:95], v[252:255], v[36:39]
    s_cmp_ge_u32 s76, 3
    s_cselect_b64 vcc, -1, 0
    v_cndmask_b32 v112, v112, v116, vcc
    v_cndmask_b32 v113, v113, v117, vcc
    s_cmp_ge_u32 s76, 1
    s_cselect_b64 vcc, -1, 0
    v_cndmask_b32 v112, 0, v112, vcc
    v_cndmask_b32 v113, 0, v113, vcc
    v_fmac_f32 v22, v20, v112
    ds_read_b64_tr_b16 v[76:77], v14 offset:8192
    ds_read_b64_tr_b16 v[78:79], v14 offset:8448
    ds_read_b64_tr_b16 v[92:93], v15 offset:8192
    ds_read_b64_tr_b16 v[94:95], v15 offset:8448
    v_mfma_f32_16x16x32_bf16 v[32:35], v[124:127], v[52:55], v[32:35]
    v_fmac_f32 v23, v20, v113
    v_fma_f32 v22, -v21, v113, v22
    v_fmac_f32 v23, v21, v112
    v_mfma_f32_16x16x32_bf16 v[36:39], v[124:127], v[54:57], v[36:39]
    s_add_u32 m0, s85, 3072
    s_add_u32 s10, s25, 16384
    buffer_load_dwordx4 v10, s[16:19], s10 offen sc1 lds
    s_add_u32 m0, s85, 4096
    s_add_u32 s10, s25, 24576
    buffer_load_dwordx4 v11, s[16:19], s10 offen sc1 lds
    s_mul_i32 s6, s100, 56
    s_mul_i32 s7, s3, 7
    s_min_u32 s7, s7, 49
    s_add_u32 s6, s6, s7
    s_add_u32 s6, s6, 0
    s_lshl_b32 s6, s6, 10
    s_lshr_b32 s7, s79, 2
    s_lshl_b32 s7, s7, 9
    s_add_u32 s6, s6, s7
    v_min_u32 v7, 27, v1
    v_lshrrev_b32 v8, 2, v7
    v_and_b32 v7, 3, v7
    v_lshlrev_b32 v7, 7, v7
    v_lshl_add_u32 v7, v8, 10, v7
    s_mov_b32 m0, 122880
    s_nop 0
    buffer_load_dword v7, s[68:71], s6 offen lds
    s_waitcnt lgkmcnt(14)
    v_mfma_f32_16x16x32_bf16 v[120:123], v[56:59], v[64:67], 0
    v_mfma_f32_16x16x32_bf16 v[40:43], v[64:67], v[128:131], 0
    v_mul_f32 v112, v60, v32
    v_mul_f32 v113, v60, v33
    v_mul_f32 v114, v60, v34
    v_mfma_f32_16x16x32_bf16 v[44:47], v[64:67], v[192:195], 0
    v_mul_f32 v115, v60, v35
    v_exp_f32 v112, v112
    ds_read_b64_tr_b16 v[64:65], v16 offset:5120
    ds_read_b64_tr_b16 v[66:67], v16 offset:5376
    s_waitcnt lgkmcnt(12)
    v_mfma_f32_16x16x32_bf16 v[120:123], v[56:59], v[68:71], v[120:123]
    v_exp_f32 v113, v113
    v_exp_f32 v114, v114
    v_exp_f32 v115, v115
    v_mfma_f32_16x16x32_bf16 v[40:43], v[68:71], v[144:147], v[40:43]
    v_fma_f32 v112, v112, v53, v53
    v_fma_f32 v113, v113, v53, v53
    v_mfma_f32_16x16x32_bf16 v[44:47], v[68:71], v[208:211], v[44:47]
    v_fma_f32 v114, v114, v53, v53
    v_fma_f32 v115, v115, v53, v53
    v_rcp_f32 v112, v112
    ds_read_b64_tr_b16 v[68:69], v16 offset:6144
    ds_read_b64_tr_b16 v[70:71], v16 offset:6400
    s_waitcnt lgkmcnt(10)
    v_mfma_f32_16x16x32_bf16 v[120:123], v[56:59], v[72:75], v[120:123]
    v_rcp_f32 v113, v113
    v_rcp_f32 v114, v114
    v_mfma_f32_16x16x32_bf16 v[40:43], v[72:75], v[160:163], v[40:43]
    v_rcp_f32 v115, v115
    v_mul_f32 v32, v32, v112
    v_mfma_f32_16x16x32_bf16 v[44:47], v[72:75], v[224:227], v[44:47]
    v_mul_f32 v33, v33, v113
    v_mul_f32 v34, v34, v114
    v_mul_f32 v35, v35, v115
    ds_read_b64_tr_b16 v[72:73], v16 offset:7168
    ds_read_b64_tr_b16 v[74:75], v16 offset:7424
    s_waitcnt lgkmcnt(8)
    v_mfma_f32_16x16x32_bf16 v[120:123], v[56:59], v[76:79], v[120:123]
    v_cvt_pk_bf16_f32 v32, v32, v33
    v_cvt_pk_bf16_f32 v33, v34, v35
    v_mfma_f32_16x16x32_bf16 v[40:43], v[76:79], v[176:179], v[40:43]
    v_mul_f32 v112, v61, v36
    v_mul_f32 v113, v61, v37
    v_mul_f32 v114, v61, v38
    v_mfma_f32_16x16x32_bf16 v[44:47], v[76:79], v[240:243], v[44:47]
    v_mul_f32 v115, v61, v39
    v_exp_f32 v112, v112
    ds_read_b64_tr_b16 v[76:77], v16 offset:8192
    ds_read_b64_tr_b16 v[78:79], v16 offset:8448
    v_mfma_f32_16x16x32_bf16 v[40:43], v[80:83], v[132:135], v[40:43]
    v_exp_f32 v113, v113
    v_exp_f32 v114, v114
    v_mfma_f32_16x16x32_bf16 v[44:47], v[80:83], v[196:199], v[44:47]
    v_exp_f32 v115, v115
    v_fma_f32 v112, v112, v55, v55
    v_fma_f32 v113, v113, v55, v55
    ds_read_b64_tr_b16 v[80:81], v17 offset:5120
    ds_read_b64_tr_b16 v[82:83], v17 offset:5376
    v_mfma_f32_16x16x32_bf16 v[40:43], v[84:87], v[148:151], v[40:43]
    v_fma_f32 v114, v114, v55, v55
    v_fma_f32 v115, v115, v55, v55
    v_mfma_f32_16x16x32_bf16 v[44:47], v[84:87], v[212:215], v[44:47]
    v_rcp_f32 v112, v112
    v_rcp_f32 v113, v113
    v_rcp_f32 v114, v114
    ds_read_b64_tr_b16 v[84:85], v17 offset:6144
    ds_read_b64_tr_b16 v[86:87], v17 offset:6400
    v_cvt_pk_bf16_f32 v121, v120, v120
    ds_write_b16 v12, v121 offset:41728
    v_mfma_f32_16x16x32_bf16 v[40:43], v[88:91], v[164:167], v[40:43]
    v_rcp_f32 v115, v115
    v_mul_f32 v36, v36, v112
    v_mfma_f32_16x16x32_bf16 v[44:47], v[88:91], v[228:231], v[44:47]
    v_mul_f32 v37, v37, v113
    v_mul_f32 v38, v38, v114
    ds_read_b64_tr_b16 v[88:89], v17 offset:7168
    ds_read_b64_tr_b16 v[90:91], v17 offset:7424
    s_waitcnt lgkmcnt(15)
    v_mfma_f32_16x16x32_bf16 v[40:43], v[92:95], v[180:183], v[40:43]
    v_mul_f32 v39, v39, v115
    v_cvt_pk_bf16_f32 v34, v36, v37
    v_cvt_pk_bf16_f32 v35, v38, v39
    v_mfma_f32_16x16x32_bf16 v[44:47], v[92:95], v[244:247], v[44:47]
    v_permlane16_swap_b32 v32, v34
    v_permlane16_swap_b32 v33, v35
    ds_read_b64_tr_b16 v[92:93], v17 offset:8192
    ds_read_b64_tr_b16 v[94:95], v17 offset:8448
    s_waitcnt lgkmcnt(15)
    v_mfma_f32_16x16x32_bf16 v[40:43], v[64:67], v[136:139], v[40:43]
    buffer_store_dwordx4 v[32:35], v31, s[60:63], s82 offen sc1
    s_add_u32 s82, s82, 8192
    v_lshrrev_b32 v5, 5, v1
    v_bfe_u32 v6, v1, 3, 1
    v_mfma_f32_16x16x32_bf16 v[44:47], v[64:67], v[200:203], v[44:47]
    v_and_b32 v8, 6, v1
    v_xor_b32 v4, v5, v8
    s_waitcnt lgkmcnt(13)
    v_mfma_f32_16x16x32_bf16 v[40:43], v[68:71], v[152:155], v[40:43]
    v_xor_b32 v4, v4, v6
    s_and_b32 s6, s97, 6
    v_xor_b32 v4, s6, v4
    v_mfma_f32_16x16x32_bf16 v[44:47], v[68:71], v[216:219], v[44:47]
    v_lshlrev_b32 v4, 4, v4
    v_and_b32 v7, 31, v1
    v_lshl_add_u32 v8, v7, 7, s85
    s_waitcnt lgkmcnt(11)
    v_mfma_f32_16x16x32_bf16 v[40:43], v[72:75], v[168:171], v[40:43]
    v_add_u32 v18, v4, v8
    v_xor_b32 v19, 32, v18
    v_mfma_f32_16x16x32_bf16 v[44:47], v[72:75], v[232:235], v[44:47]
    v_xor_b32 v20, 64, v18
    v_xor_b32 v21, 96, v18
    v_and_b32 v4, 1, v3
    s_waitcnt lgkmcnt(9)
    v_mfma_f32_16x16x32_bf16 v[40:43], v[76:79], v[184:187], v[40:43]
    v_mul_u32_u24 v4, 72, v4
    v_xor_b32 v26, v4, v31
    v_mfma_f32_16x16x32_bf16 v[44:47], v[76:79], v[248:251], v[44:47]
    s_lshl_b32 s6, s78, 6
    s_lshl_b32 s7, s76, 3
    s_add_u32 s6, s6, s7
    v_lshl_add_u32 v0, v5, 2, s6
    v_lshlrev_b32 v0, 2, v0
    s_waitcnt vmcnt(12) lgkmcnt(0)
    s_barrier
    ds_read_b32 v124, v13 offset:41728
    v_mfma_f32_16x16x32_bf16 v[40:43], v[80:83], v[140:143], v[40:43]
    v_mfma_f32_16x16x32_bf16 v[44:47], v[80:83], v[204:207], v[44:47]
    s_add_u32 m0, s85, 5120
    s_add_u32 s10, s24, 0
    buffer_load_dwordx4 v10, s[20:23], s10 offen sc1 lds
    ds_read_b64_tr_b16 v[64:65], v14 offset:9216
    ds_read_b64_tr_b16 v[66:67], v14 offset:9472
    ds_read_b64_tr_b16 v[80:81], v15 offset:9216
    ds_read_b64_tr_b16 v[82:83], v15 offset:9472
    v_mfma_f32_16x16x32_bf16 v[40:43], v[84:87], v[156:159], v[40:43]
    v_mfma_f32_16x16x32_bf16 v[44:47], v[84:87], v[220:223], v[44:47]
    s_add_u32 m0, s85, 6144
    s_add_u32 s10, s24, 8192
    buffer_load_dwordx4 v11, s[20:23], s10 offen sc1 lds
    ds_read_b64_tr_b16 v[68:69], v14 offset:10240
    ds_read_b64_tr_b16 v[70:71], v14 offset:10496
    ds_read_b64_tr_b16 v[84:85], v15 offset:10240
    ds_read_b64_tr_b16 v[86:87], v15 offset:10496
    v_mfma_f32_16x16x32_bf16 v[40:43], v[88:91], v[172:175], v[40:43]
    v_mfma_f32_16x16x32_bf16 v[44:47], v[88:91], v[236:239], v[44:47]
    s_add_u32 m0, s85, 7168
    s_add_u32 s10, s24, 16384
    buffer_load_dwordx4 v10, s[20:23], s10 offen sc1 lds
    ds_read_b64_tr_b16 v[72:73], v14 offset:11264
    ds_read_b64_tr_b16 v[74:75], v14 offset:11520
    ds_read_b64_tr_b16 v[88:89], v15 offset:11264
    ds_read_b64_tr_b16 v[90:91], v15 offset:11520
    s_waitcnt lgkmcnt(12)
    v_bfe_u32 v124, v124, s101, 16
    v_mfma_f32_16x16x32_bf16 v[40:43], v[92:95], v[188:191], v[40:43]
    v_mfma_f32_16x16x32_bf16 v[44:47], v[92:95], v[252:255], v[44:47]
    s_add_u32 m0, s85, 8192
    s_add_u32 s10, s24, 24576
    buffer_load_dwordx4 v11, s[20:23], s10 offen sc1 lds
    ds_read_b64_tr_b16 v[76:77], v14 offset:12288
    ds_read_b64_tr_b16 v[78:79], v14 offset:12544
    ds_read_b64_tr_b16 v[92:93], v15 offset:12288
    ds_read_b64_tr_b16 v[94:95], v15 offset:12544
    v_mfma_f32_16x16x32_bf16 v[40:43], v[124:127], v[52:55], v[40:43]
    v_mfma_f32_16x16x32_bf16 v[44:47], v[124:127], v[54:57], v[44:47]
    s_waitcnt lgkmcnt(14)
    v_mfma_f32_16x16x32_bf16 v[120:123], v[56:59], v[64:67], 0
    v_mfma_f32_16x16x32_bf16 v[32:35], v[64:67], v[128:131], 0
    s_nop 3
    v_mul_f32 v112, v60, v40
    v_mul_f32 v113, v60, v41
    v_mfma_f32_16x16x32_bf16 v[36:39], v[64:67], v[192:195], 0
    v_mul_f32 v114, v60, v42
    v_mul_f32 v115, v60, v43
    ds_read_b64_tr_b16 v[64:65], v16 offset:9216
    ds_read_b64_tr_b16 v[66:67], v16 offset:9472
    s_waitcnt lgkmcnt(12)
    v_mfma_f32_16x16x32_bf16 v[120:123], v[56:59], v[68:71], v[120:123]
    v_exp_f32 v112, v112
    v_exp_f32 v113, v113
    v_mfma_f32_16x16x32_bf16 v[32:35], v[68:71], v[144:147], v[32:35]
    v_exp_f32 v114, v114
    v_exp_f32 v115, v115
    v_mfma_f32_16x16x32_bf16 v[36:39], v[68:71], v[208:211], v[36:39]
    v_fma_f32 v112, v112, v53, v53
    ds_read_b64_tr_b16 v[68:69], v16 offset:10240
    ds_read_b64_tr_b16 v[70:71], v16 offset:10496
    s_waitcnt lgkmcnt(10)
    v_mfma_f32_16x16x32_bf16 v[120:123], v[56:59], v[72:75], v[120:123]
    v_fma_f32 v113, v113, v53, v53
    v_fma_f32 v114, v114, v53, v53
    v_mfma_f32_16x16x32_bf16 v[32:35], v[72:75], v[160:163], v[32:35]
    v_fma_f32 v115, v115, v53, v53
    v_rcp_f32 v112, v112
    v_mfma_f32_16x16x32_bf16 v[36:39], v[72:75], v[224:227], v[36:39]
    v_rcp_f32 v113, v113
    v_rcp_f32 v114, v114
    ds_read_b64_tr_b16 v[72:73], v16 offset:11264
    ds_read_b64_tr_b16 v[74:75], v16 offset:11520
    s_waitcnt lgkmcnt(8)
    v_mfma_f32_16x16x32_bf16 v[120:123], v[56:59], v[76:79], v[120:123]
    v_rcp_f32 v115, v115
    v_mfma_f32_16x16x32_bf16 v[32:35], v[76:79], v[176:179], v[32:35]
    v_mul_f32 v40, v40, v112
    v_mul_f32 v41, v41, v113
    v_mfma_f32_16x16x32_bf16 v[36:39], v[76:79], v[240:243], v[36:39]
    v_mul_f32 v42, v42, v114
    v_mul_f32 v43, v43, v115
    ds_read_b64_tr_b16 v[76:77], v16 offset:12288
    ds_read_b64_tr_b16 v[78:79], v16 offset:12544
    v_mfma_f32_16x16x32_bf16 v[32:35], v[80:83], v[132:135], v[32:35]
    v_cvt_pk_bf16_f32 v40, v40, v41
    v_cvt_pk_bf16_f32 v41, v42, v43
    v_mfma_f32_16x16x32_bf16 v[36:39], v[80:83], v[196:199], v[36:39]
    v_mul_f32 v112, v61, v44
    v_mul_f32 v113, v61, v45
    ds_read_b64_tr_b16 v[80:81], v17 offset:9216
    ds_read_b64_tr_b16 v[82:83], v17 offset:9472
    s_waitcnt vmcnt(10)
    ds_read_b128 v[192:195], v18 offset:15360
    ds_read_b128 v[208:211], v19 offset:15360
    ds_read_b128 v[224:227], v20 offset:15360
    ds_read_b128 v[240:243], v21 offset:15360
    v_mfma_f32_16x16x32_bf16 v[32:35], v[84:87], v[148:151], v[32:35]
    v_mul_f32 v114, v61, v46
    v_mfma_f32_16x16x32_bf16 v[36:39], v[84:87], v[212:215], v[36:39]
    v_mul_f32 v115, v61, v47
    v_exp_f32 v112, v112
    ds_read_b64_tr_b16 v[84:85], v17 offset:10240
    ds_read_b64_tr_b16 v[86:87], v17 offset:10496
    v_cvt_pk_bf16_f32 v121, v120, v120
    ds_write_b16 v12, v121 offset:61440
    v_mfma_f32_16x16x32_bf16 v[32:35], v[88:91], v[164:167], v[32:35]
    v_exp_f32 v113, v113
    v_exp_f32 v114, v114
    v_mfma_f32_16x16x32_bf16 v[36:39], v[88:91], v[228:231], v[36:39]
    v_exp_f32 v115, v115
    s_waitcnt vmcnt(4)
    v_mov_b32 v4, 1
    s_mov_b64 exec, 1
    buffer_atomic_add v4, off, s[60:63], s34 sc1
    s_mov_b64 exec, -1
    ds_read_b64_tr_b16 v[88:89], v17 offset:11264
    ds_read_b64_tr_b16 v[90:91], v17 offset:11520
    s_waitcnt lgkmcnt(5)
    s_add_u32 m0, s85, 15360
    s_nop 0
    buffer_load_dwordx4 v27, s[68:71], s36 offen sc1 lds
    s_add_u32 m0, s85, 16384
    s_add_u32 s10, s36, 8192
    buffer_load_dwordx4 v27, s[68:71], s10 offen sc1 lds
    v_mfma_f32_16x16x32_bf16 v[32:35], v[92:95], v[180:183], v[32:35]
    v_fma_f32 v112, v112, v55, v55
    v_mfma_f32_16x16x32_bf16 v[36:39], v[92:95], v[244:247], v[36:39]
    v_fma_f32 v113, v113, v55, v55
    v_fma_f32 v114, v114, v55, v55
    ds_read_b64_tr_b16 v[92:93], v17 offset:12288
    ds_read_b64_tr_b16 v[94:95], v17 offset:12544
    s_add_u32 m0, s85, 17408
    s_nop 0
    buffer_load_dwordx4 v27, s[68:71], s37 offen sc1 lds
    s_add_u32 m0, s85, 18432
    s_add_u32 s10, s37, 8192
    buffer_load_dwordx4 v27, s[68:71], s10 offen sc1 lds
    v_mfma_f32_16x16x32_bf16 v[32:35], v[64:67], v[136:139], v[32:35]
    v_fma_f32 v115, v115, v55, v55
    v_rcp_f32 v112, v112
    v_mfma_f32_16x16x32_bf16 v[36:39], v[64:67], v[200:203], v[36:39]
    v_rcp_f32 v113, v113
    v_rcp_f32 v114, v114
    s_xor_b32 s6, s76, 0
    s_mul_i32 s6, s6, 40960
    v_lshl_add_u32 v14, v1, 3, s6
    s_xor_b32 s6, s76, 1
    s_mul_i32 s6, s6, 40960
    v_lshl_add_u32 v15, v1, 3, s6
    s_xor_b32 s6, s76, 2
    s_mul_i32 s6, s6, 40960
    v_lshl_add_u32 v16, v1, 3, s6
    s_xor_b32 s6, s76, 3
    s_mul_i32 s6, s6, 40960
    v_lshl_add_u32 v17, v1, 3, s6
    ds_read_b128 v[196:199], v18 offset:1024
    ds_read_b128 v[212:215], v19 offset:1024
    ds_read_b128 v[228:231], v20 offset:1024
    ds_read_b128 v[244:247], v21 offset:1024
    v_mfma_f32_16x16x32_bf16 v[32:35], v[68:71], v[152:155], v[32:35]
    v_rcp_f32 v115, v115
    v_mul_f32 v44, v44, v112
    v_mfma_f32_16x16x32_bf16 v[36:39], v[68:71], v[216:219], v[36:39]
    v_mul_f32 v45, v45, v113
    v_mfma_f32_16x16x32_bf16 v[32:35], v[72:75], v[168:171], v[32:35]
    v_mul_f32 v46, v46, v114
    v_mul_f32 v47, v47, v115
    v_mfma_f32_16x16x32_bf16 v[36:39], v[72:75], v[232:235], v[36:39]
    v_cvt_pk_bf16_f32 v42, v44, v45
    v_cvt_pk_bf16_f32 v43, v46, v47
    s_waitcnt lgkmcnt(0)
    s_add_u32 m0, s85, 1024
    s_nop 0
    buffer_load_dwordx4 v27, s[68:71], s38 offen sc1 lds
    s_add_u32 m0, s85, 2048
    s_add_u32 s10, s38, 8192
    buffer_load_dwordx4 v27, s[68:71], s10 offen sc1 lds
    v_mfma_f32_16x16x32_bf16 v[32:35], v[76:79], v[184:187], v[32:35]
    v_permlane16_swap_b32 v40, v42
    v_permlane16_swap_b32 v41, v43
    v_mfma_f32_16x16x32_bf16 v[36:39], v[76:79], v[248:251], v[36:39]
    buffer_store_dwordx4 v[40:43], v31, s[60:63], s82 offen sc1
    s_add_u32 s82, s82, 8192
    s_add_u32 m0, s85, 3072
    s_nop 0
    buffer_load_dwordx4 v27, s[68:71], s39 offen sc1 lds
    s_add_u32 m0, s85, 4096
    s_add_u32 s10, s39, 8192
    buffer_load_dwordx4 v27, s[68:71], s10 offen sc1 lds
    s_waitcnt lgkmcnt(0)
    s_barrier
    ds_read_b32 v124, v13 offset:61440
    v_mfma_f32_16x16x32_bf16 v[32:35], v[80:83], v[140:143], v[32:35]
    v_mfma_f32_16x16x32_bf16 v[36:39], v[80:83], v[204:207], v[36:39]
    s_buffer_load_dword s96, s[60:63], s35 glc
    v_lshlrev_b32 v116, 12, v3
    ds_read_b64_tr_b16 v[64:65], v14 offset:13312
    ds_read_b64_tr_b16 v[66:67], v14 offset:13824
    ds_read_b64_tr_b16 v[80:81], v15 offset:13312
    ds_read_b64_tr_b16 v[82:83], v15 offset:13824
    s_add_u32 m0, s85, 9216
    s_add_u32 s10, s25, 0
    buffer_load_dwordx4 v10, s[20:23], s10 offen sc1 lds
    s_add_u32 m0, s85, 10240
    s_add_u32 s10, s25, 8192
    buffer_load_dwordx4 v11, s[20:23], s10 offen sc1 lds
    s_add_u32 m0, s85, 11264
    s_add_u32 s10, s25, 16384
    buffer_load_dwordx4 v10, s[20:23], s10 offen sc1 lds
    s_add_u32 m0, s85, 12288
    s_add_u32 s10, s25, 24576
    buffer_load_dwordx4 v11, s[20:23], s10 offen sc1 lds
    v_mfma_f32_16x16x32_bf16 v[32:35], v[84:87], v[156:159], v[32:35]
    v_lshl_add_u32 v116, v2, 3, v116
    v_mfma_f32_16x16x32_bf16 v[36:39], v[84:87], v[220:223], v[36:39]
    v_add_u32 v118, 16384, v116
    ds_read_b64_tr_b16 v[68:69], v14 offset:33792
    ds_read_b64_tr_b16 v[70:71], v14 offset:34304
    ds_read_b64_tr_b16 v[84:85], v15 offset:33792
    ds_read_b64_tr_b16 v[86:87], v15 offset:34304
    s_waitcnt vmcnt(14)
    ds_read_b128 v[200:203], v18 offset:5120
    ds_read_b128 v[216:219], v19 offset:5120
    ds_read_b128 v[232:235], v20 offset:5120
    ds_read_b128 v[248:251], v21 offset:5120
    v_mfma_f32_16x16x32_bf16 v[32:35], v[88:91], v[172:175], v[32:35]
    v_add_u32 v44, 32768, v116
    v_mfma_f32_16x16x32_bf16 v[36:39], v[88:91], v[236:239], v[36:39]
    v_add_u32 v46, 49152, v116
    ds_read_b64_tr_b16 v[72:73], v14 offset:14336
    ds_read_b64_tr_b16 v[74:75], v14 offset:14848
    ds_read_b64_tr_b16 v[88:89], v15 offset:14336
    ds_read_b64_tr_b16 v[90:91], v15 offset:14848
    s_waitcnt lgkmcnt(15)
    v_bfe_u32 v124, v124, s101, 16
    v_mfma_f32_16x16x32_bf16 v[32:35], v[92:95], v[188:191], v[32:35]
    buffer_load_dwordx2 v[118:119], v118, s[60:63], s28 offen sc1
    v_mfma_f32_16x16x32_bf16 v[36:39], v[92:95], v[252:255], v[36:39]
    buffer_load_dwordx2 v[44:45], v44, s[60:63], s28 offen sc1
    ds_read_b64_tr_b16 v[76:77], v14 offset:34816
    ds_read_b64_tr_b16 v[78:79], v14 offset:35328
    ds_read_b64_tr_b16 v[92:93], v15 offset:34816
    ds_read_b64_tr_b16 v[94:95], v15 offset:35328
    s_waitcnt lgkmcnt(8)
    s_add_u32 m0, s85, 5120
    s_add_u32 s10, s36, 32768
    buffer_load_dwordx4 v27, s[68:71], s10 offen sc1 lds
    s_add_u32 m0, s85, 6144
    s_add_u32 s10, s36, 40960
    buffer_load_dwordx4 v27, s[68:71], s10 offen sc1 lds
    s_add_u32 m0, s85, 7168
    s_add_u32 s10, s37, 32768
    buffer_load_dwordx4 v27, s[68:71], s10 offen sc1 lds
    s_add_u32 m0, s85, 8192
    s_add_u32 s10, s37, 40960
    buffer_load_dwordx4 v27, s[68:71], s10 offen sc1 lds
    v_mfma_f32_16x16x32_bf16 v[32:35], v[124:127], v[52:55], v[32:35]
    buffer_load_dwordx2 v[46:47], v46, s[60:63], s28 offen sc1
    v_mfma_f32_16x16x32_bf16 v[36:39], v[124:127], v[54:57], v[36:39]
    buffer_load_dwordx2 v[116:117], v116, s[60:63], s28 offen sc1
    v_mfma_f32_16x16x32_bf16 v[120:123], v[56:59], v[64:67], 0
    v_mfma_f32_16x16x32_bf16 v[40:43], v[64:67], v[128:131], 0
    s_nop 2
    v_mul_f32 v112, v60, v32
    v_mul_f32 v113, v60, v33
    v_mul_f32 v114, v60, v34
    v_mul_f32 v115, v60, v35
    v_exp_f32 v112, v112
    v_exp_f32 v113, v113
    ds_read_b64_tr_b16 v[64:65], v16 offset:13312
    ds_read_b64_tr_b16 v[66:67], v16 offset:13824
    v_mfma_f32_16x16x32_bf16 v[120:123], v[56:59], v[68:71], v[120:123]
    v_exp_f32 v114, v114
    v_exp_f32 v115, v115
    v_fma_f32 v112, v112, v53, v53
    v_fma_f32 v113, v113, v53, v53
    v_fma_f32 v114, v114, v53, v53
    v_fma_f32 v115, v115, v53, v53
    v_mfma_f32_16x16x32_bf16 v[40:43], v[68:71], v[144:147], v[40:43]
    v_rcp_f32 v112, v112
    v_rcp_f32 v113, v113
    v_rcp_f32 v114, v114
    v_rcp_f32 v115, v115
    v_mul_f32 v32, v32, v112
    ds_read_b64_tr_b16 v[68:69], v16 offset:33792
    ds_read_b64_tr_b16 v[70:71], v16 offset:34304
    s_waitcnt lgkmcnt(10)
    v_mfma_f32_16x16x32_bf16 v[120:123], v[56:59], v[72:75], v[120:123]
    v_mul_f32 v33, v33, v113
    v_mul_f32 v34, v34, v114
    v_mul_f32 v35, v35, v115
    v_cvt_pk_bf16_f32 v32, v32, v33
    v_cvt_pk_bf16_f32 v33, v34, v35
    v_mul_f32 v112, v61, v36
    v_mfma_f32_16x16x32_bf16 v[40:43], v[72:75], v[160:163], v[40:43]
    v_mul_f32 v113, v61, v37
    v_mul_f32 v114, v61, v38
    v_mul_f32 v115, v61, v39
    v_exp_f32 v112, v112
    v_exp_f32 v113, v113
    v_exp_f32 v114, v114
    ds_read_b64_tr_b16 v[72:73], v16 offset:14336
    ds_read_b64_tr_b16 v[74:75], v16 offset:14848
    s_waitcnt lgkmcnt(8)
    v_mfma_f32_16x16x32_bf16 v[120:123], v[56:59], v[76:79], v[120:123]
    v_exp_f32 v115, v115
    v_fma_f32 v112, v112, v55, v55
    s_waitcnt vmcnt(14)
    v_mov_b32 v4, 16
    s_mov_b64 exec, 1
    buffer_atomic_add v4, off, s[60:63], s34 sc1
    s_mov_b64 exec, -1
    v_fma_f32 v113, v113, v55, v55
    v_fma_f32 v114, v114, v55, v55
    v_mfma_f32_16x16x32_bf16 v[40:43], v[76:79], v[176:179], v[40:43]
    v_fma_f32 v115, v115, v55, v55
    v_rcp_f32 v112, v112
    v_rcp_f32 v113, v113
    v_rcp_f32 v114, v114
    v_rcp_f32 v115, v115
    v_mul_f32 v36, v36, v112
    ds_read_b64_tr_b16 v[76:77], v16 offset:34816
    ds_read_b64_tr_b16 v[78:79], v16 offset:35328
    v_mfma_f32_16x16x32_bf16 v[40:43], v[80:83], v[132:135], v[40:43]
    v_mul_f32 v37, v37, v113
    v_mul_f32 v38, v38, v114
    v_mul_f32 v39, v39, v115
    v_cvt_pk_bf16_f32 v34, v36, v37
    v_cvt_pk_bf16_f32 v35, v38, v39
    s_nop 0
    v_permlane16_swap_b32 v32, v34
    ds_read_b64_tr_b16 v[80:81], v17 offset:13312
    ds_read_b64_tr_b16 v[82:83], v17 offset:13824
    v_mfma_f32_16x16x32_bf16 v[40:43], v[84:87], v[148:151], v[40:43]
    v_permlane16_swap_b32 v33, v35
    buffer_store_dwordx4 v[32:35], v31, s[60:63], s82 offen sc1
    s_add_u32 s82, s82, 8192
    s_lshl_b32 s6, s76, 5
    v_lshl_add_u32 v8, v3, 3, s6
    v_cvt_f32_u32 v8, v8
    ds_read_b64_tr_b16 v[84:85], v17 offset:33792
    ds_read_b64_tr_b16 v[86:87], v17 offset:34304
    v_cvt_pk_bf16_f32 v121, v120, v120
    ds_write_b16 v12, v121 offset:61696
    v_mfma_f32_16x16x32_bf16 v[40:43], v[88:91], v[164:167], v[40:43]
    v_mul_f32 v4, v8, v62
    v_mul_f32 v5, v8, v63
    v_exp_f32 v4, v4
    v_fract_f32 v5, v5
    v_cos_f32 v32, v5
    v_sin_f32 v33, v5
    ds_read_b64_tr_b16 v[88:89], v17 offset:14336
    ds_read_b64_tr_b16 v[90:91], v17 offset:14848
    s_waitcnt vmcnt(10)
    ds_read_b128 v[204:207], v18 offset:9216
    ds_read_b128 v[220:223], v19 offset:9216
    ds_read_b128 v[236:239], v20 offset:9216
    ds_read_b128 v[252:255], v21 offset:9216
    s_waitcnt lgkmcnt(15)
    v_mfma_f32_16x16x32_bf16 v[40:43], v[92:95], v[180:183], v[40:43]
    v_mul_f32 v32, v32, v4
    v_mul_f32 v33, v33, v4
    v_mul_f32 v4, 0x44000000, v62
    v_mul_f32 v5, 0x44000000, v63
    v_exp_f32 v4, v4
    v_fract_f32 v5, v5
    ds_read_b64_tr_b16 v[92:93], v17 offset:34816
    ds_read_b64_tr_b16 v[94:95], v17 offset:35328
    v_mfma_f32_16x16x32_bf16 v[40:43], v[64:67], v[136:139], v[40:43]
    v_cos_f32 v36, v5
    v_sin_f32 v37, v5
    v_mul_f32 v36, v36, v4
    v_mul_f32 v37, v37, v4
    s_sub_u32 s6, s4, 1
    v_sub_u32 v8, s6, v3
    s_waitcnt lgkmcnt(2)
    s_add_u32 m0, s85, 9216
    s_add_u32 s10, s38, 32768
    buffer_load_dwordx4 v27, s[68:71], s10 offen sc1 lds
    s_add_u32 m0, s85, 10240
    s_add_u32 s10, s38, 40960
    buffer_load_dwordx4 v27, s[68:71], s10 offen sc1 lds
    v_mfma_f32_16x16x32_bf16 v[40:43], v[68:71], v[152:155], v[40:43]
    v_cmp_le_i32 s[44:45], 0, v8
    v_cmp_le_i32 s[46:47], 4, v8
    v_cmp_le_i32 s[8:9], 8, v8
    v_cmp_le_i32 s[12:13], 12, v8
    v_and_b32 v8, 3, v8
    v_lshlrev_b32 v8, 7, v8
    s_add_u32 m0, s85, 11264
    s_add_u32 s10, s39, 32768
    buffer_load_dwordx4 v27, s[68:71], s10 offen sc1 lds
    s_add_u32 m0, s85, 12288
    s_add_u32 s10, s39, 40960
    buffer_load_dwordx4 v27, s[68:71], s10 offen sc1 lds
    v_mfma_f32_16x16x32_bf16 v[40:43], v[72:75], v[168:171], v[40:43]
    v_cvt_f32_u32 v8, v8
    v_mul_f32 v4, v8, v62
    v_mul_f32 v5, v8, v63
    v_exp_f32 v4, v4
    v_fract_f32 v5, v5
    v_cos_f32 v34, v5
    v_mfma_f32_16x16x32_bf16 v[40:43], v[76:79], v[184:187], v[40:43]
    v_sin_f32 v35, v5
    v_mul_f32 v34, v34, v4
    v_mul_f32 v35, v35, v4
    s_lshl_b32 s6, s76, 3
    v_xor_b32 v8, s6, v1
    v_lshlrev_b32 v10, 4, v8
    s_waitcnt lgkmcnt(0)
    s_barrier
    ds_read_b32 v124, v13 offset:61696
    v_mfma_f32_16x16x32_bf16 v[40:43], v[80:83], v[140:143], v[40:43]
    v_mfma_f32_16x16x32_bf16 v[40:43], v[84:87], v[156:159], v[40:43]
    s_buffer_load_dword s96, s[60:63], s35 glc
    ds_read_b128 v[64:67], v0 offset:20480
    v_mfma_f32_16x16x32_bf16 v[40:43], v[88:91], v[172:175], v[40:43]
    ds_read_b128 v[68:71], v0 offset:20608
    s_waitcnt lgkmcnt(2)
    v_bfe_u32 v124, v124, s101, 16
    v_mfma_f32_16x16x32_bf16 v[40:43], v[92:95], v[188:191], v[40:43]
    ds_read_b32 v12, v0
    s_add_u32 m0, s85, 13312
    s_add_u32 s10, s36, 65536
    buffer_load_dwordx4 v27, s[68:71], s10 offen sc1 lds
    v_mfma_f32_16x16x32_bf16 v[40:43], v[124:127], v[52:55], v[40:43]
    s_add_u32 m0, s85, 14336
    s_add_u32 s10, s36, 73728
    buffer_load_dwordx4 v27, s[68:71], s10 offen sc1 lds
    s_setprio 3
    s_waitcnt vmcnt(6)
    v_mov_b32 v4, 256
    s_mov_b64 exec, 1
    buffer_atomic_add v4, off, s[60:63], s34 sc1
    s_mov_b64 exec, -1
    v_mul_f32 v112, v60, v40
    v_mul_f32 v113, v60, v41
    v_mul_f32 v114, v60, v42
    v_mul_f32 v115, v60, v43
    v_exp_f32 v112, v112
    v_exp_f32 v113, v113
    v_exp_f32 v114, v114
    v_exp_f32 v115, v115
    v_fma_f32 v112, v112, v53, v53
    v_fma_f32 v113, v113, v53, v53
    v_fma_f32 v114, v114, v53, v53
    v_fma_f32 v115, v115, v53, v53
    v_rcp_f32 v112, v112
    v_rcp_f32 v113, v113
    v_rcp_f32 v114, v114
    v_rcp_f32 v115, v115
    v_mul_f32 v40, v40, v112
    v_mul_f32 v41, v41, v113
    v_mul_f32 v42, v42, v114
    v_mul_f32 v43, v43, v115
    v_cvt_pk_bf16_f32 v40, v40, v41
    v_cvt_pk_bf16_f32 v41, v42, v43
    buffer_store_dwordx2 v[40:41], v26, s[60:63], s84 offen sc1
    s_bfe_u32 s6, s96, 0x40000
    s_cmp_eq_u32 s6, 8
    s_cbranch_scc0 SPIN0
RET0:
    buffer_load_dwordx4 v[80:83], v10, s[60:63], s0 offen offset:0 sc1
    buffer_load_dwordx4 v[84:87], v10, s[60:63], s0 offen offset:1024 sc1
    buffer_load_dwordx4 v[88:91], v10, s[60:63], s1 offen offset:0 sc1
    buffer_load_dwordx4 v[92:95], v10, s[60:63], s1 offen offset:1024 sc1
    buffer_load_dwordx4 v[120:123], v10, s[60:63], s29 offen offset:0 sc1
    buffer_load_dwordx4 v[124:127], v10, s[60:63], s29 offen offset:1024 sc1
    buffer_load_dwordx4 v[56:59], v10, s[60:63], s30 offen offset:0 sc1
    buffer_load_dwordx4 v[76:79], v10, s[60:63], s30 offen offset:1024 sc1
    s_mov_b32 s15, 0
EPOLL:
    v_mov_b32 v6, 1
    v_cndmask_b32 v7, 1, v116, s[44:45]
    v_and_b32 v6, v6, v7
    v_cndmask_b32 v7, 1, v118, s[46:47]
    v_and_b32 v6, v6, v7
    v_cndmask_b32 v7, 1, v44, s[8:9]
    v_and_b32 v6, v6, v7
    v_cndmask_b32 v7, 1, v46, s[12:13]
    v_and_b32 v6, v6, v7
    v_cmp_eq_u32 vcc, 0, v6
    s_nop 0
    s_cmp_eq_u64 vcc, 0
    s_cbranch_scc1 EPOLL_OK
    s_add_u32 s15, s15, 1
    s_cmp_gt_u32 s15, 0x8000
    s_cbranch_scc1 EPOLL_OK
    s_sleep 4
    v_lshlrev_b32 v116, 12, v3
    v_lshl_add_u32 v116, v2, 3, v116
    v_add_u32 v118, 16384, v116
    v_add_u32 v44, 32768, v116
    v_add_u32 v46, 49152, v116
    buffer_load_dwordx2 v[118:119], v118, s[60:63], s28 offen sc1
    buffer_load_dwordx2 v[44:45], v44, s[60:63], s28 offen sc1
    buffer_load_dwordx2 v[46:47], v46, s[60:63], s28 offen sc1
    buffer_load_dwordx2 v[116:117], v116, s[60:63], s28 offen sc1
    s_waitcnt vmcnt(0)
    s_branch EPOLL
EPOLL_OK:
    v_cndmask_b32 v8, 0, v116, s[44:45]
    v_cndmask_b32 v9, 0, v117, s[44:45]
    v_fmac_f32 v118, v36, v8
    v_fmac_f32 v119, v36, v9
    v_fma_f32 v118, -v37, v9, v118
    v_fmac_f32 v119, v37, v8
    v_cndmask_b32 v8, v8, v118, s[46:47]
    v_cndmask_b32 v9, v9, v119, s[46:47]
    v_fmac_f32 v44, v36, v8
    v_fmac_f32 v45, v36, v9
    v_fma_f32 v44, -v37, v9, v44
    v_fmac_f32 v45, v37, v8
    v_cndmask_b32 v8, v8, v44, s[8:9]
    v_cndmask_b32 v9, v9, v45, s[8:9]
    v_fmac_f32 v46, v36, v8
    v_fmac_f32 v47, v36, v9
    v_fma_f32 v46, -v37, v9, v46
    v_fmac_f32 v47, v37, v8
    v_cndmask_b32 v8, v8, v46, s[12:13]
    v_cndmask_b32 v9, v9, v47, s[12:13]
    v_mul_f32 v6, v34, v8
    v_mul_f32 v7, v34, v9
    v_fma_f32 v6, -v35, v9, v6
    v_fmac_f32 v7, v35, v8
    v_mov_b32 v8, v6
    v_mov_b32 v9, v7
    s_nop 0
    v_permlane16_swap_b32 v8, v6
    v_permlane16_swap_b32 v9, v7
    v_add_f32 v8, v8, v6
    v_add_f32 v9, v9, v7
    v_mov_b32 v6, v8
    v_mov_b32 v7, v9
    s_nop 0
    v_permlane32_swap_b32 v8, v6
    v_permlane32_swap_b32 v9, v7
    v_add_f32 v8, v8, v6
    v_add_f32 v9, v9, v7
    v_fmac_f32 v22, v32, v8
    v_fmac_f32 v23, v32, v9
    v_fma_f32 v22, -v33, v9, v22
    v_fmac_f32 v23, v33, v8
    v_fmac_f32 v49, v24, v22
    v_fmac_f32 v51, v24, v23
    v_fma_f32 v49, -v25, v23, v49
    v_fmac_f32 v51, v25, v22
    v_fmac_f32 v96, v48, v22
    v_fmac_f32 v100, v48, v49
    v_fmac_f32 v104, v48, v23
    v_fmac_f32 v108, v48, v51
    v_fma_f32 v96, -v50, v23, v96
    v_fma_f32 v100, -v50, v51, v100
    v_fmac_f32 v104, v50, v22
    v_fmac_f32 v108, v50, v49
    v_fmac_f32 v97, v48, v96
    v_fmac_f32 v101, v48, v100
    v_fmac_f32 v105, v48, v104
    v_fmac_f32 v109, v48, v108
    v_fma_f32 v97, -v50, v104, v97
    v_fma_f32 v101, -v50, v108, v101
    v_fmac_f32 v105, v50, v96
    v_fmac_f32 v109, v50, v100
    v_mul_f32 v112, v28, v96
    v_fma_f32 v112, -v30, v104, v112
    v_mul_f32 v104, v28, v104
    v_fmac_f32 v104, v30, v96
    v_mul_f32 v114, v28, v100
    v_fma_f32 v114, -v30, v108, v114
    v_mul_f32 v108, v28, v108
    v_fmac_f32 v108, v30, v100
    v_fmac_f32 v98, v48, v97
    s_waitcnt vmcnt(8)
    v_mov_b32 v4, 4096
    s_mov_b64 exec, 1
    buffer_atomic_add v4, off, s[60:63], s34 sc1
    s_mov_b64 exec, -1
    v_fmac_f32 v102, v48, v101
    v_fmac_f32 v106, v48, v105
    v_fmac_f32 v110, v48, v109
    v_fma_f32 v98, -v50, v105, v98
    v_fma_f32 v102, -v50, v109, v102
    v_fmac_f32 v106, v50, v97
    v_fmac_f32 v110, v50, v101
    v_mul_f32 v113, v28, v97
    v_fma_f32 v113, -v30, v105, v113
    v_mul_f32 v105, v28, v105
    v_fmac_f32 v105, v30, v97
    v_mul_f32 v115, v28, v101
    v_fma_f32 v115, -v30, v109, v115
    v_mul_f32 v109, v28, v109
    v_fmac_f32 v109, v30, v101
    v_cvt_pk_bf16_f32 v96, v112, v113
    v_cvt_pk_bf16_f32 v104, -v104, -v105
    v_cvt_pk_bf16_f32 v100, v114, v115
    v_cvt_pk_bf16_f32 v108, -v108, -v109
    v_fmac_f32 v99, v48, v98
    v_fmac_f32 v103, v48, v102
    v_fmac_f32 v107, v48, v106
    v_fmac_f32 v111, v48, v110
    v_fma_f32 v99, -v50, v106, v99
    v_fma_f32 v103, -v50, v110, v103
    v_fmac_f32 v107, v50, v98
    v_fmac_f32 v111, v50, v102
    v_mul_f32 v112, v28, v98
    v_fma_f32 v112, -v30, v106, v112
    v_mul_f32 v106, v28, v106
    v_fmac_f32 v106, v30, v98
    v_mul_f32 v114, v28, v102
    v_fma_f32 v114, -v30, v110, v114
    v_mul_f32 v110, v28, v110
    v_fmac_f32 v110, v30, v102
    s_buffer_load_dword s96, s[60:63], s35 glc
    v_mul_f32 v113, v28, v99
    v_fma_f32 v113, -v30, v107, v113
    v_mul_f32 v107, v28, v107
    v_fmac_f32 v107, v30, v99
    v_mul_f32 v115, v28, v103
    v_fma_f32 v115, -v30, v111, v115
    v_mul_f32 v111, v28, v111
    v_fmac_f32 v111, v30, v103
    v_cvt_pk_bf16_f32 v97, v112, v113
    v_cvt_pk_bf16_f32 v105, -v106, -v107
    v_cvt_pk_bf16_f32 v101, v114, v115
    v_cvt_pk_bf16_f32 v109, -v110, -v111
    s_add_u32 s6, s85, 19456
    v_lshlrev_b32 v4, 6, v2
    v_lshl_add_u32 v4, v3, 4, v4
    v_add_u32 v4, s6, v4
    ds_write2_b64 v4, v[96:97], v[100:101] offset0:0 offset1:1
    v_lshrrev_b32 v5, 5, v1
    v_bfe_u32 v6, v1, 2, 2
    v_lshl_add_u32 v7, v5, 3, v6
    v_lshlrev_b32 v5, 6, v7
    v_and_b32 v6, 1, v3
    v_lshl_add_u32 v5, v6, 5, v5
    v_and_b32 v6, 3, v1
    v_lshl_add_u32 v5, v6, 3, v5
    v_add_u32 v5, s6, v5
    ds_read_b64_tr_b16 v[96:97], v5
    ds_read_b64_tr_b16 v[98:99], v5 offset:256
    ds_write2_b64 v4, v[104:105], v[108:109] offset0:0 offset1:1
    ds_read_b64_tr_b16 v[104:105], v5
    ds_read_b64_tr_b16 v[106:107], v5 offset:256
    ds_read_b32 v12, v0
    v_lshlrev_b32 v4, 4, v1
    v_lshl_add_u32 v5, v7, 7, s85
    v_and_b32 v8, 1, v1
    v_lshl_add_u32 v5, v8, 3, v5
    v_bfe_u32 v6, v1, 4, 1
    v_lshlrev_b32 v6, 1, v6
    s_waitcnt lgkmcnt(4)
    buffer_store_dwordx4 v[96:99], v4, s[60:63], s27 offen sc1
    v_bfe_u32 v8, v1, 1, 1
    v_add_u32 v6, v6, v8
    v_bfe_u32 v8, v1, 3, 1
    v_xor_b32 v8, s77, v8
    s_waitcnt lgkmcnt(1)
    buffer_store_dwordx4 v[104:107], v4, s[60:63], s27 offen offset:1024 sc1
    v_lshlrev_b32 v8, 2, v8
    v_xor_b32 v6, v6, v8
    v_lshl_add_u32 v14, v6, 4, v5
    v_xor_b32 v15, 64, v14
    ds_read_b64_tr_b16 v[32:33], v14 offset:15360
    ds_read_b64_tr_b16 v[34:35], v14 offset:15872
    ds_read_b64_tr_b16 v[36:37], v15 offset:15360
    ds_read_b64_tr_b16 v[38:39], v15 offset:15872
    ds_read_b32 v12, v0
    s_bfe_u32 s6, s96, 0x40004
    s_cmp_eq_u32 s6, 8
    s_cbranch_scc0 SPIN1
RET1:
    s_add_u32 s6, s0, 8192
    buffer_load_dwordx4 v[108:111], v10, s[60:63], s6 offen offset:0 sc1
    s_add_u32 s6, s0, 8192
    buffer_load_dwordx4 v[112:115], v10, s[60:63], s6 offen offset:1024 sc1
    s_add_u32 s6, s1, 8192
    buffer_load_dwordx4 v[116:119], v10, s[60:63], s6 offen offset:0 sc1
    s_add_u32 s6, s1, 8192
    buffer_load_dwordx4 v[48:51], v10, s[60:63], s6 offen offset:1024 sc1
    s_add_u32 s6, s29, 8192
    buffer_load_dwordx4 v[60:63], v10, s[60:63], s6 offen offset:0 sc1
    s_add_u32 s6, s29, 8192
    buffer_load_dwordx4 v[52:55], v10, s[60:63], s6 offen offset:1024 sc1
    s_add_u32 s6, s30, 8192
    buffer_load_dwordx4 v[100:103], v10, s[60:63], s6 offen offset:0 sc1
    s_add_u32 s6, s30, 8192
    buffer_load_dwordx4 v[96:99], v10, s[60:63], s6 offen offset:1024 sc1
    s_lshl_b32 s6, s4, 7
    s_lshl_b32 s7, s78, 6
    s_add_u32 s6, s6, s7
    s_lshl_b32 s7, s76, 3
    s_add_u32 s6, s6, s7
    v_lshrrev_b32 v5, 5, v1
    v_lshl_add_u32 v5, v5, 2, s6
    s_lshl_b32 s7, s77, 5
    s_lshl_b32 s10, s79, 6
    s_add_u32 s7, s7, s10
    v_and_b32 v7, 31, v1
    v_add_u32 v7, s7, v7
    v_lshlrev_b32 v24, 1, v7
    s_lshl_b32 s6, s6, 9
    s_add_u32 s6, s6, s7
    s_lshl_b32 s14, s6, 1
    v_lshl_add_u32 v5, v5, 9, v7
    v_lshlrev_b32 v26, 2, v5
    v_lshl_add_u32 v17, v1, 4, s85
    s_setprio 2
    s_waitcnt vmcnt(17)
    s_waitcnt lgkmcnt(1)
    v_mfma_f32_32x32x16_bf16 v[128:143], v[80:83], v[32:35], 0
    ds_read_b64_tr_b16 v[40:41], v14 offset:17408
    ds_read_b64_tr_b16 v[42:43], v14 offset:17920
    ds_read_b64_tr_b16 v[44:45], v15 offset:17408
    ds_read_b64_tr_b16 v[46:47], v15 offset:17920
    ds_read_b32 v12, v17
    s_buffer_load_dword s96, s[60:63], s35 glc
    v_mfma_f32_32x32x16_bf16 v[160:175], v[84:87], v[32:35], 0
    v_mfma_f32_32x32x16_bf16 v[144:159], v[80:83], v[36:39], 0
    v_mfma_f32_32x32x16_bf16 v[176:191], v[84:87], v[36:39], 0
    s_waitcnt vmcnt(15)
    s_waitcnt lgkmcnt(1)
    v_mfma_f32_32x32x16_bf16 v[128:143], v[88:91], v[40:43], v[128:143]
    ds_read_b64_tr_b16 v[32:33], v14 offset:1024
    ds_read_b64_tr_b16 v[34:35], v14 offset:1536
    ds_read_b64_tr_b16 v[36:37], v15 offset:1024
    ds_read_b64_tr_b16 v[38:39], v15 offset:1536
    ds_read_b32 v12, v17
    s_bfe_u32 s6, s96, 0x40008
    s_cmp_eq_u32 s6, 8
    s_cbranch_scc0 SPIN2
RET2:
    s_add_u32 s6, s0, 16384
    buffer_load_dwordx4 v[104:107], v10, s[60:63], s6 offen offset:0 sc1
    v_mfma_f32_32x32x16_bf16 v[160:175], v[92:95], v[40:43], v[160:175]
    s_xor_b32 s6, s3, 1
    s_mul_i32 s6, s6, 20480
    v_lshl_add_u32 v0, v1, 4, s6
    s_xor_b32 s6, s3, 2
    s_mul_i32 s6, s6, 20480
    v_lshl_add_u32 v18, v1, 4, s6
    s_xor_b32 s6, s3, 3
    s_mul_i32 s6, s6, 20480
    v_lshl_add_u32 v19, v1, 4, s6
    v_mfma_f32_32x32x16_bf16 v[144:159], v[88:91], v[44:47], v[144:159]
    s_xor_b32 s6, s3, 4
    s_mul_i32 s6, s6, 20480
    v_lshl_add_u32 v20, v1, 4, s6
    s_xor_b32 s6, s3, 5
    s_mul_i32 s6, s6, 20480
    v_lshl_add_u32 v21, v1, 4, s6
    v_mfma_f32_32x32x16_bf16 v[176:191], v[92:95], v[44:47], v[176:191]
    s_xor_b32 s6, s3, 6
    s_mul_i32 s6, s6, 20480
    v_lshl_add_u32 v22, v1, 4, s6
    s_xor_b32 s6, s3, 7
    s_mul_i32 s6, s6, 20480
    v_lshl_add_u32 v23, v1, 4, s6
    s_waitcnt vmcnt(9)
    v_mov_b32 v16, 65536
    s_mov_b64 exec, 1
    buffer_atomic_add v16, off, s[60:63], s34 sc1
    s_mov_b64 exec, -1
    s_waitcnt lgkmcnt(1)
    v_mfma_f32_32x32x16_bf16 v[128:143], v[120:123], v[32:35], v[128:143]
    ds_read_b64_tr_b16 v[40:41], v14 offset:3072
    ds_read_b64_tr_b16 v[42:43], v14 offset:3584
    ds_read_b64_tr_b16 v[44:45], v15 offset:3072
    ds_read_b64_tr_b16 v[46:47], v15 offset:3584
    ds_read_b32 v12, v17
    v_mfma_f32_32x32x16_bf16 v[160:175], v[124:127], v[32:35], v[160:175]
    v_mfma_f32_32x32x16_bf16 v[144:159], v[120:123], v[36:39], v[144:159]
    v_mfma_f32_32x32x16_bf16 v[176:191], v[124:127], v[36:39], v[176:191]
    s_add_u32 m0, s85, 15360
    s_add_u32 s10, s37, 65536
    buffer_load_dwordx4 v27, s[68:71], s10 offen sc1 lds
    s_waitcnt lgkmcnt(1)
    v_mfma_f32_32x32x16_bf16 v[128:143], v[56:59], v[40:43], v[128:143]
    ds_read_b64_tr_b16 v[32:33], v14 offset:5120
    ds_read_b64_tr_b16 v[34:35], v14 offset:5632
    ds_read_b64_tr_b16 v[36:37], v15 offset:5120
    ds_read_b64_tr_b16 v[38:39], v15 offset:5632
    global_load_ushort v24, v24, s[32:33]
    v_lshrrev_b32 v13, 5, v1
    v_bfe_u32 v4, v1, 2, 3
    v_mfma_f32_32x32x16_bf16 v[160:175], v[76:79], v[40:43], v[160:175]
    v_lshl_add_u32 v13, v13, 5, v4
    v_and_b32 v4, 3, v1
    v_lshlrev_b32 v4, 4, v4
    v_lshl_add_u32 v13, v13, 10, v4
    v_mfma_f32_32x32x16_bf16 v[144:159], v[56:59], v[44:47], v[144:159]
    s_add_u32 m0, s85, 19456
    s_nop 0
    buffer_load_dwordx4 v13, s[48:51], s14 offen lds
    v_lshrrev_b32 v4, 5, v1
    v_lshl_add_u32 v4, v4, 8, s85
    v_mfma_f32_32x32x16_bf16 v[176:191], v[76:79], v[44:47], v[176:191]
    v_and_b32 v13, 31, v1
    v_lshl_add_u32 v13, v13, 1, v4
    s_add_u32 m0, s85, 16384
    s_add_u32 s10, s37, 73728
    buffer_load_dwordx4 v27, s[68:71], s10 offen sc1 lds
    s_add_u32 s6, s1, 16384
    buffer_load_dwordx4 v[80:83], v10, s[60:63], s6 offen offset:0 sc1
    s_waitcnt vmcnt(13)
    s_waitcnt lgkmcnt(0)
    v_mfma_f32_32x32x16_bf16 v[128:143], v[108:111], v[32:35], v[128:143]
    ds_read_b64_tr_b16 v[40:41], v14 offset:7168
    ds_read_b64_tr_b16 v[42:43], v14 offset:7680
    ds_read_b64_tr_b16 v[44:45], v15 offset:7168
    ds_read_b64_tr_b16 v[46:47], v15 offset:7680
    v_mfma_f32_32x32x16_bf16 v[160:175], v[112:115], v[32:35], v[160:175]
    s_add_u32 m0, s85, 17408
    s_add_u32 s10, s38, 65536
    buffer_load_dwordx4 v27, s[68:71], s10 offen sc1 lds
    v_mfma_f32_32x32x16_bf16 v[144:159], v[108:111], v[36:39], v[144:159]
    v_mfma_f32_32x32x16_bf16 v[176:191], v[112:115], v[36:39], v[176:191]
    s_add_u32 m0, s85, 18432
    s_add_u32 s10, s38, 73728
    buffer_load_dwordx4 v27, s[68:71], s10 offen sc1 lds
    s_waitcnt vmcnt(13)
    s_waitcnt lgkmcnt(0)
    s_setprio 1
    v_mfma_f32_32x32x16_bf16 v[128:143], v[116:119], v[40:43], v[128:143]
    ds_read_b64_tr_b16 v[32:33], v14 offset:9216
    ds_read_b64_tr_b16 v[34:35], v14 offset:9728
    ds_read_b64_tr_b16 v[36:37], v15 offset:9216
    ds_read_b64_tr_b16 v[38:39], v15 offset:9728
    ds_read_b32 v12, v17
    s_buffer_load_dword s96, s[60:63], s35 glc
    v_mfma_f32_32x32x16_bf16 v[160:175], v[48:51], v[40:43], v[160:175]
    v_mfma_f32_32x32x16_bf16 v[144:159], v[116:119], v[44:47], v[144:159]
    v_mfma_f32_32x32x16_bf16 v[176:191], v[48:51], v[44:47], v[176:191]
    s_add_u32 s6, s29, 16384
    buffer_load_dwordx4 v[84:87], v10, s[60:63], s6 offen offset:0 sc1
    s_waitcnt vmcnt(12)
    s_waitcnt lgkmcnt(1)
    v_mfma_f32_32x32x16_bf16 v[128:143], v[60:63], v[32:35], v[128:143]
    ds_read_b64_tr_b16 v[40:41], v14 offset:11264
    ds_read_b64_tr_b16 v[42:43], v14 offset:11776
    ds_read_b64_tr_b16 v[44:45], v15 offset:11264
    ds_read_b64_tr_b16 v[46:47], v15 offset:11776
    ds_read_b32 v12, v17
    v_mfma_f32_32x32x16_bf16 v[160:175], v[52:55], v[32:35], v[160:175]
    s_add_u32 m0, s85, 1024
    s_add_u32 s10, s39, 65536
    buffer_load_dwordx4 v27, s[68:71], s10 offen sc1 lds
    v_mfma_f32_32x32x16_bf16 v[144:159], v[60:63], v[36:39], v[144:159]
    v_mfma_f32_32x32x16_bf16 v[176:191], v[52:55], v[36:39], v[176:191]
    s_add_u32 m0, s85, 2048
    s_add_u32 s10, s39, 73728
    buffer_load_dwordx4 v27, s[68:71], s10 offen sc1 lds
    s_waitcnt vmcnt(12)
    s_waitcnt lgkmcnt(1)
    v_mfma_f32_32x32x16_bf16 v[128:143], v[100:103], v[40:43], v[128:143]
    ds_read_b64_tr_b16 v[32:33], v14 offset:13312
    ds_read_b64_tr_b16 v[34:35], v14 offset:13824
    ds_read_b64_tr_b16 v[36:37], v15 offset:13312
    ds_read_b64_tr_b16 v[38:39], v15 offset:13824
    ds_read_b32 v12, v17
    v_mfma_f32_32x32x16_bf16 v[160:175], v[96:99], v[40:43], v[160:175]
    s_add_u32 s6, s30, 16384
    buffer_load_dwordx4 v[88:91], v10, s[60:63], s6 offen offset:0 sc1
    v_mfma_f32_32x32x16_bf16 v[144:159], v[100:103], v[44:47], v[144:159]
    v_mfma_f32_32x32x16_bf16 v[176:191], v[96:99], v[44:47], v[176:191]
    s_add_u32 m0, s85, 3072
    s_nop 0
    buffer_load_dwordx4 v27, s[68:71], s40 offen sc1 lds
    s_waitcnt vmcnt(8)
    s_waitcnt lgkmcnt(1)
    v_mfma_f32_32x32x16_bf16 v[128:143], v[104:107], v[32:35], v[128:143]
    ds_read_b64_tr_b16 v[40:41], v14 offset:15360
    ds_read_b64_tr_b16 v[42:43], v14 offset:15872
    ds_read_b64_tr_b16 v[44:45], v15 offset:15360
    ds_read_b64_tr_b16 v[46:47], v15 offset:15872
    s_add_u32 m0, s85, 4096
    s_add_u32 s10, s40, 8192
    buffer_load_dwordx4 v27, s[68:71], s10 offen sc1 lds
    ds_read_u16 v72, v13 offset:19456
    ds_read_u16 v4, v13 offset:19520
    ds_read_u16 v73, v13 offset:19584
    v_mfma_f32_32x32x16_bf16 v[144:159], v[104:107], v[36:39], v[144:159]
    ds_read_u16 v5, v13 offset:19648
    ds_read_u16 v74, v13 offset:19968
    ds_read_u16 v6, v13 offset:20032
    ds_read_u16 v75, v13 offset:20096
    ds_read_u16 v7, v13 offset:20160
    s_waitcnt vmcnt(6)
    s_waitcnt lgkmcnt(8)
    v_mfma_f32_32x32x16_bf16 v[128:143], v[80:83], v[40:43], v[128:143]
    ds_read_b64_tr_b16 v[32:33], v14 offset:17408
    ds_read_b64_tr_b16 v[34:35], v14 offset:17920
    ds_read_b64_tr_b16 v[36:37], v15 offset:17408
    ds_read_b64_tr_b16 v[38:39], v15 offset:17920
    s_bfe_u32 s6, s96, 0x4000c
    s_cmp_eq_u32 s6, 8
    s_cbranch_scc0 SPIN3
RET3:
    buffer_load_dwordx4 v[92:95], v10, s[60:63], s31 offen offset:0 sc1
    s_waitcnt lgkmcnt(4)
    v_lshl_or_b32 v72, v4, 16, v72
    v_lshl_or_b32 v73, v5, 16, v73
    v_lshl_or_b32 v74, v6, 16, v74
    v_lshl_or_b32 v75, v7, 16, v75
    v_lshlrev_b32 v24, 16, v24
    v_mfma_f32_32x32x16_bf16 v[144:159], v[80:83], v[44:47], v[144:159]
    v_lshlrev_b32 v8, 16, v64
    v_rcp_f32 v8, v8
    v_and_b32 v4, 0xffff0000, v64
    v_lshlrev_b32 v6, 16, v72
    v_add_f32 v4, v6, v4
    v_cvt_pk_bf16_f32 v4, 0, v4
    v_mul_f32 v4, v4, v8
    v_cvt_pk_bf16_f32 v4, 0, v4
    v_mul_f32 v4, v4, v24
    s_waitcnt vmcnt(4)
    s_waitcnt lgkmcnt(0)
    v_mfma_f32_32x32x16_bf16 v[128:143], v[84:87], v[32:35], v[128:143]
    ds_read_b64_tr_b16 v[40:41], v14 offset:1024
    ds_read_b64_tr_b16 v[42:43], v14 offset:1536
    ds_read_b64_tr_b16 v[44:45], v15 offset:1024
    ds_read_b64_tr_b16 v[46:47], v15 offset:1536
    ds_read_b32 v12, v17
    s_buffer_load_dword s96, s[60:63], s35 glc
    s_add_u32 m0, s85, 5120
    s_nop 0
    buffer_load_dwordx4 v27, s[68:71], s41 offen sc1 lds
    s_add_u32 m0, s85, 6144
    s_add_u32 s10, s41, 8192
    buffer_load_dwordx4 v27, s[68:71], s10 offen sc1 lds
    v_lshlrev_b32 v9, 16, v65
    v_rcp_f32 v9, v9
    v_and_b32 v5, 0xffff0000, v65
    v_and_b32 v7, 0xffff0000, v72
    v_mfma_f32_32x32x16_bf16 v[144:159], v[84:87], v[36:39], v[144:159]
    v_add_f32 v5, v7, v5
    v_cvt_pk_bf16_f32 v5, 0, v5
    v_mul_f32 v5, v5, v9
    v_cvt_pk_bf16_f32 v5, 0, v5
    v_mul_f32 v5, v5, v24
    v_cvt_pk_bf16_f32 v64, v4, v5
    s_waitcnt vmcnt(3)
    s_waitcnt lgkmcnt(1)
    v_mfma_f32_32x32x16_bf16 v[128:143], v[88:91], v[40:43], v[128:143]
    ds_read_b64_tr_b16 v[32:33], v14 offset:3072
    ds_read_b64_tr_b16 v[34:35], v14 offset:3584
    ds_read_b64_tr_b16 v[36:37], v15 offset:3072
    ds_read_b64_tr_b16 v[38:39], v15 offset:3584
    ds_read_b32 v12, v17
    buffer_load_dwordx4 v[120:123], v10, s[60:63], s89 offen offset:0 sc1
    s_add_u32 s6, s0, 16384
    buffer_load_dwordx4 v[124:127], v10, s[60:63], s6 offen offset:1024 sc1
    s_add_u32 s6, s1, 16384
    buffer_load_dwordx4 v[56:59], v10, s[60:63], s6 offen offset:1024 sc1
    v_lshlrev_b32 v8, 16, v66
    v_rcp_f32 v8, v8
    v_and_b32 v4, 0xffff0000, v66
    v_mfma_f32_32x32x16_bf16 v[144:159], v[88:91], v[44:47], v[144:159]
    v_lshlrev_b32 v6, 16, v73
    v_add_f32 v4, v6, v4
    v_cvt_pk_bf16_f32 v4, 0, v4
    v_mul_f32 v4, v4, v8
    v_cvt_pk_bf16_f32 v4, 0, v4
    v_mul_f32 v4, v4, v24
    s_waitcnt vmcnt(3)
    s_waitcnt lgkmcnt(1)
    v_mfma_f32_32x32x16_bf16 v[128:143], v[92:95], v[32:35], v[128:143]
    ds_read_b64_tr_b16 v[40:41], v14 offset:5120
    ds_read_b64_tr_b16 v[42:43], v14 offset:5632
    ds_read_b64_tr_b16 v[44:45], v15 offset:5120
    ds_read_b64_tr_b16 v[46:47], v15 offset:5632
    ds_read_b32 v12, v17
    s_add_u32 s6, s29, 16384
    buffer_load_dwordx4 v[108:111], v10, s[60:63], s6 offen offset:1024 sc1
    s_add_u32 s6, s30, 16384
    buffer_load_dwordx4 v[112:115], v10, s[60:63], s6 offen offset:1024 sc1
    buffer_load_dwordx4 v[116:119], v10, s[60:63], s31 offen offset:1024 sc1
    v_lshlrev_b32 v9, 16, v67
    v_rcp_f32 v9, v9
    v_and_b32 v5, 0xffff0000, v67
    v_mfma_f32_32x32x16_bf16 v[144:159], v[92:95], v[36:39], v[144:159]
    v_and_b32 v7, 0xffff0000, v73
    v_add_f32 v5, v7, v5
    v_cvt_pk_bf16_f32 v5, 0, v5
    v_mul_f32 v5, v5, v9
    v_cvt_pk_bf16_f32 v5, 0, v5
    v_mul_f32 v5, v5, v24
    v_cvt_pk_bf16_f32 v65, v4, v5
    s_waitcnt vmcnt(5)
    s_waitcnt lgkmcnt(1)
    s_setprio 0
    v_mfma_f32_32x32x16_bf16 v[128:143], v[120:123], v[40:43], v[128:143]
    ds_read_b64_tr_b16 v[32:33], v14 offset:13312
    ds_read_b64_tr_b16 v[34:35], v14 offset:13824
    ds_read_b64_tr_b16 v[36:37], v15 offset:13312
    ds_read_b64_tr_b16 v[38:39], v15 offset:13824
    buffer_load_dwordx4 v[48:51], v10, s[60:63], s89 offen offset:1024 sc1
    v_lshlrev_b32 v8, 16, v68
    v_rcp_f32 v8, v8
    v_and_b32 v4, 0xffff0000, v68
    v_lshlrev_b32 v6, 16, v74
    v_mfma_f32_32x32x16_bf16 v[144:159], v[120:123], v[44:47], v[144:159]
    v_add_f32 v4, v6, v4
    v_cvt_pk_bf16_f32 v4, 0, v4
    v_mul_f32 v4, v4, v8
    v_cvt_pk_bf16_f32 v4, 0, v4
    v_mul_f32 v4, v4, v24
    s_waitcnt vmcnt(5)
    s_waitcnt lgkmcnt(0)
    v_mfma_f32_32x32x16_bf16 v[160:175], v[124:127], v[32:35], v[160:175]
    ds_read_b64_tr_b16 v[40:41], v14 offset:15360
    ds_read_b64_tr_b16 v[42:43], v14 offset:15872
    ds_read_b64_tr_b16 v[44:45], v15 offset:15360
    ds_read_b64_tr_b16 v[46:47], v15 offset:15872
    s_bfe_u32 s6, s96, 0x40010
    s_cmp_eq_u32 s6, 8
    s_cbranch_scc0 SPIN4
RET4:
    s_xor_b32 s6, s88, 0
    s_add_u32 s6, s6, s26
    buffer_load_dwordx4 v[60:63], v10, s[60:63], s6 offen sc1
    v_lshlrev_b32 v9, 16, v69
    v_rcp_f32 v9, v9
    v_and_b32 v5, 0xffff0000, v69
    v_and_b32 v7, 0xffff0000, v74
    v_add_f32 v5, v7, v5
    v_mfma_f32_32x32x16_bf16 v[176:191], v[124:127], v[36:39], v[176:191]
    v_cvt_pk_bf16_f32 v5, 0, v5
    v_mul_f32 v5, v5, v9
    v_cvt_pk_bf16_f32 v5, 0, v5
    v_mul_f32 v5, v5, v24
    v_cvt_pk_bf16_f32 v66, v4, v5
    v_mov_b32 v76, v128
    v_mov_b32 v77, v129
    s_waitcnt vmcnt(5)
    s_waitcnt lgkmcnt(0)
    v_mfma_f32_32x32x16_bf16 v[160:175], v[56:59], v[40:43], v[160:175]
    ds_read_b64_tr_b16 v[32:33], v14 offset:17408
    ds_read_b64_tr_b16 v[34:35], v14 offset:17920
    ds_read_b64_tr_b16 v[36:37], v15 offset:17408
    ds_read_b64_tr_b16 v[38:39], v15 offset:17920
    s_xor_b32 s6, s88, 1024
    s_add_u32 s6, s6, s26
    buffer_load_dwordx4 v[52:55], v10, s[60:63], s6 offen sc1
    v_lshlrev_b32 v8, 16, v70
    v_rcp_f32 v8, v8
    v_and_b32 v4, 0xffff0000, v70
    v_lshlrev_b32 v6, 16, v75
    v_add_f32 v4, v6, v4
    v_mfma_f32_32x32x16_bf16 v[176:191], v[56:59], v[44:47], v[176:191]
    v_cvt_pk_bf16_f32 v4, 0, v4
    v_mul_f32 v4, v4, v8
    v_cvt_pk_bf16_f32 v4, 0, v4
    v_mul_f32 v4, v4, v24
    v_mov_b32 v78, v130
    v_mov_b32 v79, v131
    s_waitcnt vmcnt(5)
    s_waitcnt lgkmcnt(0)
    v_mfma_f32_32x32x16_bf16 v[160:175], v[108:111], v[32:35], v[160:175]
    ds_read_b64_tr_b16 v[40:41], v14 offset:1024
    ds_read_b64_tr_b16 v[42:43], v14 offset:1536
    ds_read_b64_tr_b16 v[44:45], v15 offset:1024
    ds_read_b64_tr_b16 v[46:47], v15 offset:1536
    s_xor_b32 s6, s88, 2048
    s_add_u32 s6, s6, s26
    buffer_load_dwordx4 v[100:103], v10, s[60:63], s6 offen sc1
    v_lshlrev_b32 v9, 16, v71
    v_rcp_f32 v9, v9
    v_and_b32 v5, 0xffff0000, v71
    v_and_b32 v7, 0xffff0000, v75
    v_add_f32 v5, v7, v5
    v_mfma_f32_32x32x16_bf16 v[176:191], v[108:111], v[36:39], v[176:191]
    v_cvt_pk_bf16_f32 v5, 0, v5
    v_mul_f32 v5, v5, v9
    v_cvt_pk_bf16_f32 v5, 0, v5
    v_mul_f32 v5, v5, v24
    v_cvt_pk_bf16_f32 v67, v4, v5
    ds_write_b128 v17, v[132:135] offset:7168
    ds_write_b128 v17, v[136:139] offset:8192
    s_waitcnt vmcnt(5)
    s_waitcnt lgkmcnt(2)
    v_mfma_f32_32x32x16_bf16 v[160:175], v[112:115], v[40:43], v[160:175]
    ds_read_b64_tr_b16 v[32:33], v14 offset:3072
    ds_read_b64_tr_b16 v[34:35], v14 offset:3584
    ds_read_b64_tr_b16 v[36:37], v15 offset:3072
    ds_read_b64_tr_b16 v[38:39], v15 offset:3584
    s_xor_b32 s6, s88, 3072
    s_add_u32 s6, s6, s26
    buffer_load_dwordx4 v[96:99], v10, s[60:63], s6 offen sc1
    v_mfma_f32_32x32x16_bf16 v[176:191], v[112:115], v[44:47], v[176:191]
    ds_write_b128 v17, v[140:143] offset:9216
    ds_write_b128 v17, v[144:147] offset:10240
    s_waitcnt vmcnt(5)
    s_waitcnt lgkmcnt(2)
    v_mfma_f32_32x32x16_bf16 v[160:175], v[116:119], v[32:35], v[160:175]
    ds_read_b64_tr_b16 v[40:41], v14 offset:5120
    ds_read_b64_tr_b16 v[42:43], v14 offset:5632
    ds_read_b64_tr_b16 v[44:45], v15 offset:5120
    ds_read_b64_tr_b16 v[46:47], v15 offset:5632
    s_xor_b32 s6, s88, 4096
    s_add_u32 s6, s6, s26
    buffer_load_dwordx4 v[104:107], v10, s[60:63], s6 offen sc1
    ds_write_b128 v17, v[148:151] offset:11264
    v_mfma_f32_32x32x16_bf16 v[176:191], v[116:119], v[36:39], v[176:191]
    ds_write_b128 v17, v[152:155] offset:12288
    ds_write_b128 v17, v[156:159] offset:19456
    s_waitcnt vmcnt(5)
    s_waitcnt lgkmcnt(3)
    v_mfma_f32_32x32x16_bf16 v[160:175], v[48:51], v[40:43], v[160:175]
    v_mfma_f32_32x32x16_bf16 v[176:191], v[48:51], v[44:47], v[176:191]
    s_xor_b32 s6, s88, 5120
    s_add_u32 s6, s6, s26
    buffer_load_dwordx4 v[80:83], v10, s[60:63], s6 offen sc1
    s_waitcnt vmcnt(5) lgkmcnt(0)
    s_barrier
    v_mfma_f32_32x32x16_bf16 v[128:143], v[60:63], v[192:195], 0
    s_xor_b32 s6, s88, 6144
    s_add_u32 s6, s6, s26
    buffer_load_dwordx4 v[88:91], v10, s[60:63], s6 offen sc1
    s_xor_b32 s6, s88, 7168
    s_add_u32 s6, s6, s26
    buffer_load_dwordx4 v[92:95], v10, s[60:63], s6 offen sc1
    s_xor_b32 s6, s88, 0
    s_add_u32 s6, s6, s26
    s_add_u32 s6, s6, 65536
    buffer_load_dwordx4 v[120:123], v10, s[60:63], s6 offen sc1
    ds_read_b128 v[32:35], v0 offset:7168
    v_mfma_f32_32x32x16_bf16 v[144:159], v[60:63], v[196:199], 0
    ds_read_b128 v[36:39], v18 offset:8192
    ds_read_b128 v[40:43], v19 offset:9216
    ds_read_b128 v[44:47], v20 offset:10240
    v_mov_b32 v84, v160
    s_waitcnt vmcnt(7)
    v_mfma_f32_32x32x16_bf16 v[128:143], v[52:55], v[200:203], v[128:143]
    s_xor_b32 s6, s88, 1024
    s_add_u32 s6, s6, s26
    s_add_u32 s6, s6, 65536
    buffer_load_dwordx4 v[124:127], v10, s[60:63], s6 offen sc1
    s_waitcnt lgkmcnt(0)
    v_add_f32 v76, v76, v32
    v_add_f32 v77, v77, v33
    v_add_f32 v78, v78, v34
    v_add_f32 v79, v79, v35
    v_add_f32 v76, v76, v36
    v_add_f32 v77, v77, v37
    v_add_f32 v78, v78, v38
    v_add_f32 v79, v79, v39
    v_add_f32 v76, v76, v40
    v_mfma_f32_32x32x16_bf16 v[144:159], v[52:55], v[204:207], v[144:159]
    v_add_f32 v77, v77, v41
    v_add_f32 v78, v78, v42
    v_add_f32 v79, v79, v43
    v_add_f32 v76, v76, v44
    v_add_f32 v77, v77, v45
    v_add_f32 v78, v78, v46
    v_add_f32 v79, v79, v47
    ds_read_b128 v[32:35], v21 offset:11264
    ds_read_b128 v[36:39], v22 offset:12288
    ds_read_b128 v[40:43], v23 offset:19456
    v_mov_b32 v85, v161
    v_mov_b32 v86, v162
    s_waitcnt vmcnt(7)
    v_mfma_f32_32x32x16_bf16 v[128:143], v[100:103], v[208:211], v[128:143]
    s_waitcnt lgkmcnt(0)
    v_add_f32 v76, v76, v32
    v_add_f32 v77, v77, v33
    v_add_f32 v78, v78, v34
    v_add_f32 v79, v79, v35
    v_add_f32 v76, v76, v36
    v_add_f32 v77, v77, v37
    v_mfma_f32_32x32x16_bf16 v[144:159], v[100:103], v[212:215], v[144:159]
    v_add_f32 v78, v78, v38
    v_add_f32 v79, v79, v39
    v_add_f32 v76, v76, v40
    v_add_f32 v77, v77, v41
    v_add_f32 v78, v78, v42
    v_add_f32 v79, v79, v43
    v_mov_b32 v87, v163
    s_waitcnt vmcnt(6)
    v_mfma_f32_32x32x16_bf16 v[128:143], v[96:99], v[216:219], v[128:143]
    s_xor_b32 s6, s88, 2048
    s_add_u32 s6, s6, s26
    s_add_u32 s6, s6, 65536
    buffer_load_dwordx4 v[56:59], v10, s[60:63], s6 offen sc1
    ds_write_b128 v17, v[164:167] offset:13312
    ds_write_b128 v17, v[168:171] offset:14336
    v_cvt_pk_bf16_f32 v76, 0, v76
    v_cvt_pk_bf16_f32 v77, 0, v77
    v_mfma_f32_32x32x16_bf16 v[144:159], v[96:99], v[220:223], v[144:159]
    v_cvt_pk_bf16_f32 v78, 0, v78
    v_cvt_pk_bf16_f32 v79, 0, v79
    v_mul_f32 v44, 0xbfb8aa3b, v76
    v_mul_f32 v45, 0xbfb8aa3b, v77
    v_mul_f32 v46, 0xbfb8aa3b, v78
    s_waitcnt vmcnt(6)
    v_mfma_f32_32x32x16_bf16 v[128:143], v[104:107], v[224:227], v[128:143]
    s_xor_b32 s6, s88, 3072
    s_add_u32 s6, s6, s26
    s_add_u32 s6, s6, 65536
    buffer_load_dwordx4 v[108:111], v10, s[60:63], s6 offen sc1
    ds_write_b128 v17, v[172:175] offset:15360
    v_mul_f32 v47, 0xbfb8aa3b, v79
    v_exp_f32 v44, v44
    v_mfma_f32_32x32x16_bf16 v[144:159], v[104:107], v[228:231], v[144:159]
    v_exp_f32 v45, v45
    v_exp_f32 v46, v46
    v_exp_f32 v47, v47
    v_add_f32 v44, 1.0, v44
    v_add_f32 v45, 1.0, v45
    s_waitcnt vmcnt(6)
    v_mfma_f32_32x32x16_bf16 v[128:143], v[80:83], v[232:235], v[128:143]
    s_xor_b32 s6, s88, 4096
    s_add_u32 s6, s6, s26
    s_add_u32 s6, s6, 65536
    buffer_load_dwordx4 v[112:115], v10, s[60:63], s6 offen sc1
    ds_write_b128 v17, v[176:179] offset:16384
    ds_write_b128 v17, v[180:183] offset:17408
    v_add_f32 v46, 1.0, v46
    v_add_f32 v47, 1.0, v47
    v_mfma_f32_32x32x16_bf16 v[144:159], v[80:83], v[236:239], v[144:159]
    v_rcp_f32 v44, v44
    v_rcp_f32 v45, v45
    v_rcp_f32 v46, v46
    v_rcp_f32 v47, v47
    v_mul_f32 v76, v76, v44
    s_waitcnt vmcnt(6)
    v_mfma_f32_32x32x16_bf16 v[128:143], v[88:91], v[240:243], v[128:143]
    ds_write_b128 v17, v[184:187] offset:18432
    ds_write_b128 v17, v[188:191] offset:1024
    v_mul_f32 v77, v77, v45
    v_mul_f32 v78, v78, v46
    v_mfma_f32_32x32x16_bf16 v[144:159], v[88:91], v[244:247], v[144:159]
    v_mul_f32 v79, v79, v47
    v_cvt_pk_bf16_f32 v76, 0, v76
    v_cvt_pk_bf16_f32 v77, 0, v77
    v_cvt_pk_bf16_f32 v78, 0, v78
    v_cvt_pk_bf16_f32 v79, 0, v79
    s_waitcnt vmcnt(5)
    v_mfma_f32_32x32x16_bf16 v[128:143], v[92:95], v[248:251], v[128:143]
    v_mfma_f32_32x32x16_bf16 v[144:159], v[92:95], v[252:255], v[144:159]
    s_xor_b32 s6, s88, 5120
    s_add_u32 s6, s6, s26
    s_add_u32 s6, s6, 65536
    buffer_load_dwordx4 v[116:119], v10, s[60:63], s6 offen sc1
    s_waitcnt vmcnt(5) lgkmcnt(0)
    s_barrier
    v_mfma_f32_32x32x16_bf16 v[160:175], v[120:123], v[192:195], 0
    s_xor_b32 s6, s88, 6144
    s_add_u32 s6, s6, s26
    s_add_u32 s6, s6, 65536
    buffer_load_dwordx4 v[48:51], v10, s[60:63], s6 offen sc1
    s_xor_b32 s6, s88, 7168
    s_add_u32 s6, s6, s26
    s_add_u32 s6, s6, 65536
    buffer_load_dwordx4 v[60:63], v10, s[60:63], s6 offen sc1
    ds_read_b128 v[32:35], v0 offset:13312
    v_mfma_f32_32x32x16_bf16 v[176:191], v[120:123], v[196:199], 0
    ds_read_b128 v[36:39], v18 offset:14336
    ds_read_b128 v[40:43], v19 offset:15360
    ds_read_b128 v[44:47], v20 offset:16384
    ds_write_b128 v17, v[132:135] offset:7168
    s_waitcnt vmcnt(6)
    v_mfma_f32_32x32x16_bf16 v[160:175], v[124:127], v[200:203], v[160:175]
    s_waitcnt lgkmcnt(1)
    v_add_f32 v84, v84, v32
    v_add_f32 v85, v85, v33
    v_add_f32 v86, v86, v34
    v_add_f32 v87, v87, v35
    v_add_f32 v84, v84, v36
    v_add_f32 v85, v85, v37
    v_add_f32 v86, v86, v38
    v_add_f32 v87, v87, v39
    v_add_f32 v84, v84, v40
    v_add_f32 v85, v85, v41
    v_mfma_f32_32x32x16_bf16 v[176:191], v[124:127], v[204:207], v[176:191]
    v_add_f32 v86, v86, v42
    v_add_f32 v87, v87, v43
    v_add_f32 v84, v84, v44
    v_add_f32 v85, v85, v45
    v_add_f32 v86, v86, v46
    v_add_f32 v87, v87, v47
    ds_read_b128 v[32:35], v21 offset:17408
    ds_read_b128 v[36:39], v22 offset:18432
    ds_read_b128 v[40:43], v23 offset:1024
    ds_write_b128 v17, v[136:139] offset:8192
    ds_write_b128 v17, v[140:143] offset:9216
    s_waitcnt vmcnt(5)
    v_mfma_f32_32x32x16_bf16 v[160:175], v[56:59], v[208:211], v[160:175]
    s_waitcnt lgkmcnt(2)
    v_add_f32 v84, v84, v32
    v_add_f32 v85, v85, v33
    v_add_f32 v86, v86, v34
    v_add_f32 v87, v87, v35
    v_add_f32 v84, v84, v36
    v_add_f32 v85, v85, v37
    v_mfma_f32_32x32x16_bf16 v[176:191], v[56:59], v[212:215], v[176:191]
    v_add_f32 v86, v86, v38
    v_add_f32 v87, v87, v39
    v_add_f32 v84, v84, v40
    v_add_f32 v85, v85, v41
    v_add_f32 v86, v86, v42
    v_add_f32 v87, v87, v43
    ds_write_b128 v17, v[144:147] offset:10240
    ds_write_b128 v17, v[148:151] offset:11264
    s_waitcnt vmcnt(4)
    v_mfma_f32_32x32x16_bf16 v[160:175], v[108:111], v[216:219], v[160:175]
    ds_write_b128 v17, v[152:155] offset:12288
    ds_write_b128 v17, v[156:159] offset:19456
    v_cvt_pk_bf16_f32 v84, 0, v84
    v_cvt_pk_bf16_f32 v85, 0, v85
    v_cvt_pk_bf16_f32 v86, 0, v86
    v_mfma_f32_32x32x16_bf16 v[176:191], v[108:111], v[220:223], v[176:191]
    v_cvt_pk_bf16_f32 v87, 0, v87
    v_mul_f32 v4, 0xbfb8aa3b, v84
    v_mul_f32 v5, 0xbfb8aa3b, v85
    v_mul_f32 v6, 0xbfb8aa3b, v86
    v_mul_f32 v7, 0xbfb8aa3b, v87
    v_exp_f32 v4, v4
    s_waitcnt vmcnt(3) lgkmcnt(0)
    s_barrier
    v_mfma_f32_32x32x16_bf16 v[160:175], v[112:115], v[224:227], v[160:175]
    ds_read_b128 v[32:35], v0 offset:7168
    ds_read_b128 v[36:39], v18 offset:8192
    ds_read_b128 v[40:43], v19 offset:9216
    ds_read_b128 v[44:47], v20 offset:10240
    v_exp_f32 v5, v5
    v_exp_f32 v6, v6
    v_mfma_f32_32x32x16_bf16 v[176:191], v[112:115], v[228:231], v[176:191]
    v_exp_f32 v7, v7
    v_add_f32 v4, 1.0, v4
    v_add_f32 v5, 1.0, v5
    v_add_f32 v6, 1.0, v6
    v_add_f32 v7, 1.0, v7
    v_rcp_f32 v4, v4
    v_rcp_f32 v5, v5
    s_waitcnt vmcnt(2)
    v_mfma_f32_32x32x16_bf16 v[160:175], v[116:119], v[232:235], v[160:175]
    s_waitcnt lgkmcnt(0)
    v_add_f32 v128, v128, v32
    v_add_f32 v129, v129, v33
    v_add_f32 v130, v130, v34
    v_add_f32 v131, v131, v35
    v_add_f32 v128, v128, v36
    v_add_f32 v129, v129, v37
    v_add_f32 v130, v130, v38
    v_add_f32 v131, v131, v39
    v_add_f32 v128, v128, v40
    v_add_f32 v129, v129, v41
    v_add_f32 v130, v130, v42
    v_add_f32 v131, v131, v43
    v_add_f32 v128, v128, v44
    v_add_f32 v129, v129, v45
    v_mfma_f32_32x32x16_bf16 v[176:191], v[116:119], v[236:239], v[176:191]
    v_add_f32 v130, v130, v46
    v_add_f32 v131, v131, v47
    ds_read_b128 v[32:35], v21 offset:11264
    ds_read_b128 v[36:39], v22 offset:12288
    ds_read_b128 v[40:43], v23 offset:19456
    v_rcp_f32 v6, v6
    v_rcp_f32 v7, v7
    v_mul_f32 v84, v84, v4
    v_mul_f32 v85, v85, v5
    v_mul_f32 v86, v86, v6
    v_mul_f32 v87, v87, v7
    v_cvt_pk_bf16_f32 v84, 0, v84
    v_cvt_pk_bf16_f32 v85, 0, v85
    v_cvt_pk_bf16_f32 v86, 0, v86
    v_cvt_pk_bf16_f32 v87, 0, v87
    s_waitcnt vmcnt(1)
    v_mfma_f32_32x32x16_bf16 v[160:175], v[48:51], v[240:243], v[160:175]
    s_waitcnt lgkmcnt(0)
    v_add_f32 v128, v128, v32
    v_add_f32 v129, v129, v33
    v_add_f32 v130, v130, v34
    v_add_f32 v131, v131, v35
    v_add_f32 v128, v128, v36
    v_add_f32 v129, v129, v37
    v_add_f32 v130, v130, v38
    v_add_f32 v131, v131, v39
    v_add_f32 v128, v128, v40
    v_mfma_f32_32x32x16_bf16 v[176:191], v[48:51], v[244:247], v[176:191]
    v_add_f32 v129, v129, v41
    v_add_f32 v130, v130, v42
    v_add_f32 v131, v131, v43
    v_lshlrev_b32 v136, 16, v64
    v_lshlrev_b32 v140, 16, v72
    v_and_b32 v137, 0xffff0000, v64
    v_and_b32 v141, 0xffff0000, v72
    v_lshlrev_b32 v138, 16, v65
    v_lshlrev_b32 v142, 16, v73
    v_and_b32 v139, 0xffff0000, v65
    v_and_b32 v143, 0xffff0000, v73
    s_waitcnt vmcnt(0)
    v_mfma_f32_32x32x16_bf16 v[160:175], v[60:63], v[248:251], v[160:175]
    v_fma_f32 v136, 2.0, v128, v136
    v_fma_f32 v136, v136, v76, v140
    buffer_store_dword v136, v26, s[72:75], 0 offen offset:0 sc1
    v_fma_f32 v137, 2.0, v129, v137
    v_fma_f32 v137, v137, v77, v141
    buffer_store_dword v137, v26, s[72:75], 0 offen offset:2048 sc1
    v_mfma_f32_32x32x16_bf16 v[176:191], v[60:63], v[252:255], v[176:191]
    v_fma_f32 v138, 2.0, v130, v138
    v_fma_f32 v138, v138, v78, v142
    s_mov_b32 s9, 4096
    buffer_store_dword v138, v26, s[72:75], s9 offen offset:0 sc1
    v_fma_f32 v139, 2.0, v131, v139
    v_fma_f32 v139, v139, v79, v143
    s_mov_b32 s9, 4096
    buffer_store_dword v139, v26, s[72:75], s9 offen offset:2048 sc1
    ds_write_b128 v17, v[164:167] offset:13312
    ds_write_b128 v17, v[168:171] offset:14336
    ds_write_b128 v17, v[172:175] offset:15360
    s_nop 0
    ds_write_b128 v17, v[176:179] offset:16384
    ds_write_b128 v17, v[180:183] offset:17408
    ds_write_b128 v17, v[184:187] offset:18432
    ds_write_b128 v17, v[188:191] offset:1024
    v_lshlrev_b32 v136, 16, v66
    v_lshlrev_b32 v140, 16, v74
    v_and_b32 v137, 0xffff0000, v66
    v_and_b32 v141, 0xffff0000, v74
    v_lshlrev_b32 v138, 16, v67
    v_lshlrev_b32 v142, 16, v75
    v_and_b32 v139, 0xffff0000, v67
    v_and_b32 v143, 0xffff0000, v75
    s_waitcnt lgkmcnt(0)
    s_barrier
    ds_read_b128 v[32:35], v0 offset:13312
    ds_read_b128 v[36:39], v18 offset:14336
    ds_read_b128 v[40:43], v19 offset:15360
    ds_read_b128 v[44:47], v20 offset:16384
    ds_read_b128 v[144:147], v21 offset:17408
    ds_read_b128 v[148:151], v22 offset:18432
    ds_read_b128 v[152:155], v23 offset:1024
    s_waitcnt lgkmcnt(6)
    v_add_f32 v160, v160, v32
    v_add_f32 v161, v161, v33
    v_add_f32 v162, v162, v34
    v_add_f32 v163, v163, v35
    s_waitcnt lgkmcnt(5)
    v_add_f32 v160, v160, v36
    v_add_f32 v161, v161, v37
    v_add_f32 v162, v162, v38
    v_add_f32 v163, v163, v39
    s_waitcnt lgkmcnt(4)
    v_add_f32 v160, v160, v40
    v_add_f32 v161, v161, v41
    v_add_f32 v162, v162, v42
    v_add_f32 v163, v163, v43
    s_waitcnt lgkmcnt(3)
    v_add_f32 v160, v160, v44
    v_add_f32 v161, v161, v45
    v_add_f32 v162, v162, v46
    v_add_f32 v163, v163, v47
    s_waitcnt lgkmcnt(2)
    v_add_f32 v160, v160, v144
    v_add_f32 v161, v161, v145
    v_add_f32 v162, v162, v146
    v_add_f32 v163, v163, v147
    s_waitcnt lgkmcnt(1)
    v_add_f32 v160, v160, v148
    v_add_f32 v161, v161, v149
    v_add_f32 v162, v162, v150
    v_add_f32 v163, v163, v151
    s_waitcnt lgkmcnt(0)
    v_add_f32 v160, v160, v152
    v_add_f32 v161, v161, v153
    v_add_f32 v162, v162, v154
    v_add_f32 v163, v163, v155
    v_fma_f32 v136, 2.0, v160, v136
    v_fma_f32 v136, v136, v84, v140
    s_mov_b32 s9, 65536
    buffer_store_dword v136, v26, s[72:75], s9 offen offset:0 sc1
    v_fma_f32 v137, 2.0, v161, v137
    v_fma_f32 v137, v137, v85, v141
    s_mov_b32 s9, 65536
    buffer_store_dword v137, v26, s[72:75], s9 offen offset:2048 sc1
    v_fma_f32 v138, 2.0, v162, v138
    v_fma_f32 v138, v138, v86, v142
    s_mov_b32 s9, 69632
    buffer_store_dword v138, v26, s[72:75], s9 offen offset:0 sc1
    v_fma_f32 v139, 2.0, v163, v139
    v_fma_f32 v139, v139, v87, v143
    s_mov_b32 s9, 69632
    buffer_store_dword v139, v26, s[72:75], s9 offen offset:2048 sc1
K_END:
    s_endpgm
SPIN0:
    s_mov_b32 s15, 0
SPL0:
    s_add_u32 s15, s15, 1
    s_cmp_gt_u32 s15, 0x8000
    s_cbranch_scc1 RET0
    s_buffer_load_dword s96, s[60:63], s35 glc
    s_waitcnt lgkmcnt(0)
    s_bfe_u32 s6, s96, 0x40000
    s_cmp_eq_u32 s6, 8
    s_cbranch_scc0 SPL0
    s_branch RET0
SPIN1:
    s_mov_b32 s15, 0
SPL1:
    s_add_u32 s15, s15, 1
    s_cmp_gt_u32 s15, 0x8000
    s_cbranch_scc1 RET1
    s_buffer_load_dword s96, s[60:63], s35 glc
    s_waitcnt lgkmcnt(0)
    s_bfe_u32 s6, s96, 0x40004
    s_cmp_eq_u32 s6, 8
    s_cbranch_scc0 SPL1
    s_branch RET1
SPIN2:
    s_mov_b32 s15, 0
SPL2:
    s_add_u32 s15, s15, 1
    s_cmp_gt_u32 s15, 0x8000
    s_cbranch_scc1 RET2
    s_buffer_load_dword s96, s[60:63], s35 glc
    s_waitcnt lgkmcnt(0)
    s_bfe_u32 s6, s96, 0x40008
    s_cmp_eq_u32 s6, 8
    s_cbranch_scc0 SPL2
    s_branch RET2
SPIN3:
    s_mov_b32 s15, 0
SPL3:
    s_add_u32 s15, s15, 1
    s_cmp_gt_u32 s15, 0x8000
    s_cbranch_scc1 RET3
    s_buffer_load_dword s96, s[60:63], s35 glc
    s_waitcnt lgkmcnt(0)
    s_bfe_u32 s6, s96, 0x4000c
    s_cmp_eq_u32 s6, 8
    s_cbranch_scc0 SPL3
    s_branch RET3
SPIN4:
    s_mov_b32 s15, 0
SPL4:
    s_add_u32 s15, s15, 1
    s_cmp_gt_u32 s15, 0x8000
    s_cbranch_scc1 RET4
    s_buffer_load_dword s96, s[60:63], s35 glc
    s_waitcnt lgkmcnt(0)
    s_bfe_u32 s6, s96, 0x40010
    s_cmp_eq_u32 s6, 8
    s_cbranch_scc0 SPL4
    s_branch RET4
CODE_END:
.section .rodata,"a"
.p2align 6
.amdhsa_kernel recurrent_scan__ssm_conv_s5__dense_activation_silu__prompt_kernel
  .amdhsa_next_free_vgpr 256
  .amdhsa_next_free_sgpr 102
  .amdhsa_accum_offset 256
  .amdhsa_group_segment_fixed_size 0
  .amdhsa_kernarg_size 120
  .amdhsa_user_sgpr_count 2
  .amdhsa_user_sgpr_kernarg_segment_ptr 1
  .amdhsa_system_sgpr_workgroup_id_x 1
.end_amdhsa_kernel
```
